```python
import torch

def _softmax(x, axis=-1):
    return torch.softmax(x, dim=axis)
def _gelu(x):
    return torch.nn.functional.gelu(x, approximate="tanh")
def _silu(x):
    return torch.nn.functional.silu(x)
def _sigmoid(x):
    return torch.sigmoid(x)
def _layernorm(x, axis=-1, eps=1e-5):
    m = x.mean(dim=axis, keepdim=True)
    v = x.var(dim=axis, keepdim=True, unbiased=False)
    return (x - m) / torch.sqrt(v + eps)
def _scatter_add(tgt, idx, src, axis=0):
    return tgt.clone().index_add_(axis, idx, src)
def _segment_sum(src, seg, n):
    out = torch.zeros((n,) + src.shape[1:], dtype=src.dtype)
    return out.index_add_(0, seg, src)
def _pad(x, pw):
    flat = tuple(v for pair in reversed(pw) for v in pair)
    return torch.nn.functional.pad(x, flat)

kernel_name = 'gated_mix__softmax_full_mha__swiglu_ffn__prompt'

def setup_inputs():

    _w = (lambda a: (lambda t: t.to(torch.bfloat16) if t.is_floating_point() else t)(torch.as_tensor(a)))
    def _A_setup():
        B, S, D = 1, 2048, 512
        return {
            "x": _w((lambda *s: torch.randn(*s, dtype=torch.bfloat16) * 0.05)(B, S, D)),
            "wqkv": _w((lambda *s: torch.randn(*s, dtype=torch.bfloat16) * 0.8)(D, 3 * D)),
            "wo": _w((lambda *s: torch.randn(*s, dtype=torch.bfloat16) * 0.05)(D, D)),
        }
    _A_in = _A_setup()

    def _B_setup():
        B, S, D, F = 1, 2048, 512, 1792
        return {
            "x": _w((lambda *s: torch.randn(*s, dtype=torch.bfloat16) * 0.05)(B, S, D)),
            "w_gate": _w((lambda *s: torch.randn(*s, dtype=torch.bfloat16) * 0.1)(D, F)),
            "w_up": _w((lambda *s: torch.randn(*s, dtype=torch.bfloat16) * 0.1)(D, F)),
            "w_down": _w((lambda *s: torch.randn(*s, dtype=torch.bfloat16) * 0.1)(F, D)),
        }
    _B_in = _B_setup()

    return {
        "A_x": _A_in["x"],
        "A_wqkv": _A_in["wqkv"],
        "A_wo": _A_in["wo"],
        "B_x": _B_in["x"],
        "B_w_gate": _B_in["w_gate"],
        "B_w_up": _B_in["w_up"],
        "B_w_down": _B_in["w_down"],
        "gate_w": _w((lambda *s: torch.randn(*s, dtype=torch.bfloat16) * 0.05)(512) * 16.0),
    }

def reference(A_x, A_wqkv, A_wo, B_x, B_w_gate, B_w_up, B_w_down, gate_w):
    def _A_ref(x, wqkv, wo):
        B, S, D = x.shape
        H = 32; Dh = D // H
        qkv = (lambda x, *d: x.permute(*d))((x @ wqkv).reshape(B, S, 3, H, Dh), 2, 0, 3, 1, 4)
        q, k, v = qkv[0], qkv[1], qkv[2]
        scale = Dh ** -0.5
        scores = torch.einsum("bhqd,bhkd->bhqk", q, k) * scale
        p = _softmax(scores, axis=-1)
        o = torch.einsum("bhqk,bhkd->bhqd", p, v)
        return (lambda x, *d: x.permute(*d))(o, 0, 2, 1, 3).reshape(B, S, D) @ wo

    def _B_ref(x, w_gate, w_up, w_down):
        g = _silu(x @ w_gate)
        u = x @ w_up
        return (g * u) @ w_down

    x = A_x
    g = _sigmoid((x * gate_w).sum(-1, keepdims=True))
    a = _A_ref(x, A_wqkv, A_wo)
    b = _B_ref(x, B_w_gate, B_w_up, B_w_down)
    return g * a + (1 - g) * b
```

```asm
; @launch kernel=gated_mix__softmax_full_mha__swiglu_ffn__prompt_kernel grid=(256,1,1) block=(512,1,1) lds=163840
.amdgcn_target "amdgcn-amd-amdhsa--gfx950"
.text
.globl gated_mix__softmax_full_mha__swiglu_ffn__prompt_kernel
.p2align 8
.type gated_mix__softmax_full_mha__swiglu_ffn__prompt_kernel,@function
gated_mix__softmax_full_mha__swiglu_ffn__prompt_kernel:
    s_load_dwordx4 s[4:7], s[0:1], 0
    s_cmp_ge_u32 s2, 256
    s_cbranch_scc1 KF_END
    s_load_dwordx4 s[8:11], s[0:1], 32
    s_load_dwordx2 s[12:13], s[0:1], 56
    s_load_dwordx2 s[14:15], s[0:1], 80
    v_lshrrev_b32 v1, 6, v0
    v_and_b32 v0, 63, v0
    s_and_b32 s16, s2, 7
    v_readfirstlane_b32 s3, v1
    s_lshr_b32 s17, s2, 3
    s_and_b32 s18, s16, 1
    s_lshl_b32 s18, s18, 3
    s_and_b32 s19, s17, 7
    s_add_u32 s18, s18, s19
    s_lshr_b32 s54, s16, 1
    s_lshl_b32 s19, s54, 2
    s_lshr_b32 s55, s17, 3
    s_add_u32 s19, s19, s55
    s_and_b32 s36, s3, 3
    s_lshr_b32 s37, s3, 2
    v_lshlrev_b32 v1, 4, v0
    s_load_dwordx2 s[100:101], s[0:1], 72
    s_load_dwordx2 s[76:77], s[0:1], 48
    s_load_dwordx2 s[78:79], s[0:1], 16
    v_lshrrev_b32 v20, 4, v0
    v_and_b32 v21, 7, v0
    v_xor_b32 v22, v21, v20
    v_lshlrev_b32 v22, 4, v22
    v_lshrrev_b32 v23, 3, v0
    v_lshl_add_u32 v22, v23, 10, v22
    s_lshl_b32 s58, s3, 14
    v_add_u32 v11, s58, v22
    v_xor_b32 v12, 64, v11
    v_add_u32 v12, 7168, v12
    v_and_b32 v22, 1, v20
    v_lshlrev_b32 v22, 2, v22
    v_xor_b32 v22, v22, v21
    s_and_b32 s58, s3, 1
    s_lshl_b32 s58, s58, 1
    v_xor_b32 v22, s58, v22
    v_lshlrev_b32 v22, 4, v22
    s_lshl_b32 s58, s3, 3
    v_add_u32 v23, s58, v23
    v_mul_u32_u24 v24, 3072, v23
    v_add_u32 v13, v24, v22
    s_lshl_b32 s56, s3, 11
    s_lshl_b32 s57, s3, 10
    s_lshl_b32 s44, s18, 17
    s_lshl_b32 s45, s19, 7
    s_sub_u32 s46, 1572864, s45
    s_lshl_b32 s50, s55, 1
    s_add_u32 s50, s50, s18
    s_lshl_b32 s51, s54, 8
    s_sub_u32 s51, 1920, s51
    s_add_u32 s28, s55, 1
    s_waitcnt lgkmcnt(0)
    s_getpc_b64 s[90:91]
AB_PC:
    s_lshl_b32 s92, s17, 3
    s_add_u32 s92, s92, s3
    s_lshl_b32 s92, s92, 7
    s_min_u32 s92, s92, KF_LAST-AB_PC
    s_load_dword s33, s[90:91], s92
    s_add_u32 s20, s4, s44
    s_addc_u32 s21, s5, 0
    s_mov_b32 s22, 0x20000
    s_mov_b32 s23, 0x20000
    s_add_u32 s24, s6, s45
    s_addc_u32 s25, s7, 0
    s_mov_b32 s26, s46
    s_mov_b32 s27, 0x20000
    s_bitcmp1_b32 s28, 1
    s_cbranch_scc0 AB_P
    s_mov_b32 s28, s12
    s_mov_b32 s29, s13
    s_mov_b32 s30, 0x400
    s_mov_b32 s31, 0x20000
    s_lshl_b32 s60, s19, 3
    s_add_u32 s60, s60, s3
    s_lshl_b32 s39, s60, 10
    buffer_load_dwordx4 v[240:243], v1, s[28:31], 0 offen
    buffer_load_dwordx4 v[244:247], v1, s[20:23], s39 offen
    s_add_u32 m0, s56, 0x0
    s_add_u32 s48, s50, 0
    s_and_b32 s48, s48, 7
    s_mul_i32 s49, s48, 196608
    s_lshl_b32 s48, s48, 7
    buffer_load_dwordx4 v11, s[20:23], s48 offen offset:0 lds
    buffer_load_dwordx4 v12, s[20:23], s48 offen offset:1024 lds
    s_add_u32 m0, s57, 0x4000
    s_nop 0
    buffer_load_dwordx4 v13, s[24:27], s49 offen offset:0 lds
    s_add_u32 m0, s57, 0x6000
    s_add_u32 s49, s49, s51
    buffer_load_dwordx4 v13, s[24:27], s49 offen offset:0 lds
    s_barrier
    s_add_u32 m0, s56, 0x8000
    s_add_u32 s48, s50, 1
    s_and_b32 s48, s48, 7
    s_mul_i32 s49, s48, 196608
    s_lshl_b32 s48, s48, 7
    buffer_load_dwordx4 v11, s[20:23], s48 offen offset:0 lds
    buffer_load_dwordx4 v12, s[20:23], s48 offen offset:1024 lds
    s_add_u32 m0, s57, 0xc000
    s_nop 0
    buffer_load_dwordx4 v13, s[24:27], s49 offen offset:0 lds
    s_add_u32 m0, s57, 0xe000
    s_add_u32 s49, s49, s51
    buffer_load_dwordx4 v13, s[24:27], s49 offen offset:0 lds
    s_lshl_b32 s58, s55, 3
    s_lshr_b32 s38, 0x140e0800, s58
    s_and_b32 s38, s38, 0xff
    s_lshr_b32 s52, 0x00008000, s58
    s_and_b32 s52, s52, 0xff
    s_lshr_b32 s97, 0x80400080, s58
    s_and_b32 s97, s97, 0xff
    s_mul_i32 s58, s54, 28
    s_add_u32 s58, s58, s38
    s_lshl_b32 s38, s58, 5
    s_sub_u32 s39, 1835008, s38
    s_add_u32 s40, s8, s38
    s_addc_u32 s41, s9, 0
    s_mov_b32 s42, s39
    s_mov_b32 s43, 0x20000
    s_add_u32 s44, s10, s38
    s_addc_u32 s45, s11, 0
    s_mov_b32 s46, s39
    s_mov_b32 s47, 0x20000
    v_mul_u32_u24 v24, 3584, v23
    v_add_u32 v14, v24, v22
    v_lshrrev_b32 v23, 2, v0
    s_lshl_b32 s38, s36, 4
    v_add_u32 v23, s38, v23
    v_mul_u32_u24 v23, 3584, v23
    v_and_b32 v24, 3, v0
    v_lshrrev_b32 v25, 5, v0
    v_lshlrev_b32 v25, 1, v25
    v_xor_b32 v24, v25, v24
    s_cmp_eq_u32 s37, 0
    s_cselect_b32 s4, s40, s44
    s_cselect_b32 s5, s41, s45
    s_mov_b32 s6, s42
    s_mov_b32 s7, 0x20000
    v_lshl_add_u32 v16, v24, 4, v23
    v_and_b32 v24, 15, v0
    v_lshrrev_b32 v25, 4, v0
    v_bfe_u32 v26, v0, 1, 3
    v_xor_b32 v26, v25, v26
    v_lshlrev_b32 v26, 4, v26
    v_lshl_add_u32 v26, v24, 7, v26
    s_lshl_b32 s38, s36, 12
    v_add_u32 v2, s38, v26
    v_bfe_u32 v21, v0, 2, 2
    v_lshl_add_u32 v26, v25, 3, v21
    v_bfe_u32 v27, v0, 4, 1
    v_and_b32 v28, 3, v0
    v_lshlrev_b32 v28, 3, v28
    v_bfe_u32 v30, v0, 3, 1
    v_xor_b32 v23, s37, v30
    v_lshl_add_u32 v23, v23, 1, v27
    v_lshl_add_u32 v29, v23, 5, v28
    v_lshl_add_u32 v29, v26, 7, v29
    v_add_u32 v5, 16384, v29
    v_xor_b32 v6, 32, v5
    v_add_u32 v7, 65536, v29
    v_xor_b32 v8, 32, v7
    v_xor_b32 v23, s37, v27
    v_lshl_add_u32 v29, v23, 5, v28
    v_lshl_add_u32 v29, v26, 6, v29
    v_add_u32 v9, 98304, v29
    v_lshrrev_b32 v25, 5, v0
    s_lshl_b32 s90, s18, 2
    s_add_u32 s90, s90, s36
    s_lshl_b32 s91, s90, 10
    s_mul_i32 s90, s90, 112
    s_add_u32 s90, s90, s58
    s_lshr_b32 s38, s52, 5
    s_add_u32 s95, s90, s38
    s_lshr_b32 s38, s97, 5
    s_add_u32 s58, s90, s38
    s_lshl_b32 s38, s37, 1
    s_add_u32 s58, s58, s38
    s_lshl_b32 s58, s58, 10
    s_add_u32 s95, s95, s37
    s_lshl_b32 s95, s95, 10
    v_and_b32 v29, 15, v0
    v_lshlrev_b32 v29, 4, v29
    v_lshl_add_u32 v29, v25, 8, v29
    v_lshl_add_u32 v10, v27, 16, v29
    s_lshl_b32 s38, s54, 1
    s_add_u32 s38, s38, s55
    s_sub_u32 s38, s38, 1
    s_lshl_b32 s38, s38, 18
    s_add_u32 s96, s91, s38
    s_lshl_b32 s38, s37, 17
    s_add_u32 s96, s96, s38
    s_add_u32 s96, s96, 0x400000
    s_cmp_lt_u32 s19, 8
    s_cselect_b32 s92, 0x3eb8aa3b, 1.0
    s_mov_b32 s93, s92
    s_lshl_b32 s38, s19, 18
    s_add_u32 s91, s91, s38
    s_lshl_b32 s38, s37, 17
    s_add_u32 s91, s91, s38
    s_add_u32 s94, s91, 0x10000
    s_and_b32 s89, s2, 7
    s_lshl_b32 s89, s89, 2
    s_bfe_u32 s38, s2, 0x20003
    s_add_u32 s89, s89, s38
    s_lshr_b32 s88, s2, 5
    s_lshr_b32 s62, s3, 2
    s_and_b32 s63, s3, 3
    s_cmp_eq_u32 s3, 0
    s_cselect_b32 s38, 0, 0x20000
    v_mov_b32 v22, s38
    v_and_b32 v18, 15, v0
    v_lshlrev_b32 v18, 4, v18
    v_mov_b32 v21, v18
    v_lshrrev_b32 v104, 5, v0
    v_lshl_add_u32 v18, v104, 8, v18
    v_mov_b32 v19, 0xdddddddd
    s_mov_b32 s74, 0x0000ffff
    s_mov_b32 s75, 0x0000ffff
    s_add_u32 s80, s14, 0x1100000
    s_addc_u32 s81, s15, 0
    s_mov_b32 s82, 0x18000
    s_mov_b32 s83, 0x20000
    s_mov_b32 s84, s100
    s_mov_b32 s85, s101
    s_mov_b32 s86, 0x100
    s_mov_b32 s87, 0x20000
    s_lshl_b32 s73, s89, 16
    s_add_u32 s68, s14, s73
    s_addc_u32 s69, s15, 0
    s_mov_b32 s70, 0x10000
    s_mov_b32 s71, 0x20000
    s_lshl_b32 s38, s63, 14
    s_add_u32 s38, s38, s73
    s_add_u32 s39, s38, 0x200000
    s_add_u32 s8, s14, s39
    s_addc_u32 s9, s15, 0
    s_mov_b32 s10, 0x4000
    s_mov_b32 s11, 0x20000
    s_add_u32 s39, s38, 0x400000
    s_add_u32 s64, s14, s39
    s_addc_u32 s65, s15, 0
    s_mov_b32 s66, 0x4000
    s_mov_b32 s67, 0x20000
    s_lshl_b32 s72, s88, 11
    s_lshl_b32 s39, s88, 3
    s_add_u32 s38, s3, s39
    s_lshl_b32 s38, s38, 5
    s_add_u32 s38, s38, s89
    s_lshl_b32 s61, s38, 10
    s_lshl_b32 s38, s62, 2
    s_add_u32 s39, s39, s38
    s_add_u32 s38, s63, 1
    s_and_b32 s38, s38, 3
    s_add_u32 s38, s38, s39
    s_lshl_b32 s36, s38, 10
    s_add_u32 s38, s63, 2
    s_and_b32 s38, s38, 3
    s_add_u32 s38, s38, s39
    s_lshl_b32 s37, s38, 10
    s_add_u32 s38, s63, 3
    s_and_b32 s38, s38, 3
    s_add_u32 s38, s38, s39
    s_lshl_b32 s54, s38, 10
    s_add_u32 s38, s63, 4
    s_and_b32 s38, s38, 3
    s_add_u32 s38, s38, s39
    s_lshl_b32 s55, s38, 10
    v_bfe_u32 v105, v0, 4, 1
    v_lshlrev_b32 v106, 2, v105
    v_and_b32 v107, 7, v0
    v_xor_b32 v106, v106, v107
    v_lshlrev_b32 v106, 4, v106
    v_lshrrev_b32 v107, 3, v0
    v_lshl_add_u32 v23, v107, 10, v106
    s_lshl_b32 s38, s62, 13
    v_add_u32 v24, s38, v23
    v_add_u32 v25, 14336, v24
    v_bfe_u32 v107, v0, 2, 2
    v_lshl_add_u32 v106, v104, 3, v107
    v_bfe_u32 v107, v0, 1, 1
    v_lshl_add_u32 v107, v105, 1, v107
    v_bfe_u32 v108, v0, 3, 1
    v_lshl_add_u32 v107, v108, 2, v107
    v_lshlrev_b32 v107, 4, v107
    v_and_b32 v108, 1, v0
    v_lshl_add_u32 v107, v108, 3, v107
    v_lshl_add_u32 v107, v106, 7, v107
    s_lshl_b32 s16, s63, 12
    s_add_u32 s16, s16, 65536
    v_add_u32 v26, s16, v107
    v_xor_b32 v27, 64, v26
    s_lshl_b32 s38, s62, 10
    s_add_u32 s17, s16, s38
    s_and_b32 s53, s89, 3
    s_add_u32 s59, s53, s88
    s_cmp_ge_u32 s59, 6
    s_cselect_b32 s38, 6, 0
    s_sub_u32 s59, s59, s38
    s_lshl_b32 s59, s59, 2
    s_mov_b32 s38, 0x10ba7610
    s_mov_b32 s39, 0xba76
    s_lshr_b64 s[38:39], s[38:39], s59
    s_and_b32 s99, s38, 0xffffff
    s_lshl_b32 s53, s53, 1
    s_add_u32 s59, s53, s88
    s_and_b32 s59, s59, 7
    s_lshl_b32 s59, s59, 2
    s_mov_b32 s38, 0xdc985432
    s_mov_b32 s39, s38
    s_lshr_b64 s[38:39], s[38:39], s59
    s_lshl_b32 s98, s38, 24
    s_or_b32 s98, s98, s99
    s_lshr_b32 s99, s38, 8
    s_add_u32 s53, s61, 0xe00000
    s_lshl_b32 s59, s18, 4
    s_add_u32 s59, s59, s19
    s_lshl_b32 s59, s59, 7
    s_lshl_b32 s90, s19, 4
    s_add_u32 s90, s90, s18
    s_lshl_b32 s90, s90, 7
    s_add_u32 s90, s90, 65536
    s_lshr_b32 s38, s89, 2
    v_lshlrev_b32 v106, 3, v105
    v_add_u32 v106, s38, v106
    s_lshr_b32 s39, s38, 1
    s_lshl_b32 s39, s39, 2
    s_and_b32 s38, s38, 1
    s_add_u32 s39, s39, s38
    s_add_u32 s39, s39, 1
    v_sub_u32 v107, s39, v106
    v_mul_i32_i24 v107, v107, v104
    v_add_u32 v106, v106, v107
    v_and_b32 v107, 15, v0
    v_lshl_add_u32 v106, v106, 4, v107
    v_lshlrev_b32 v106, 7, v106
    v_add_u32 v28, 65536, v106
    s_waitcnt vmcnt(8)
    v_lshlrev_b32 v250, 16, v240
    v_and_b32 v251, 0xffff0000, v240
    v_lshlrev_b32 v252, 16, v244
    v_and_b32 v253, 0xffff0000, v244
    v_mul_f32 v250, v250, v252
    v_mul_f32 v251, v251, v253
    v_cvt_pk_bf16_f32 v250, v250, v251
    v_and_b32 v251, 0xffff0000, v250
    v_lshlrev_b32 v250, 16, v250
    v_add_f32 v248, v250, v251
    v_lshlrev_b32 v250, 16, v241
    v_and_b32 v251, 0xffff0000, v241
    v_lshlrev_b32 v252, 16, v245
    v_and_b32 v253, 0xffff0000, v245
    v_mul_f32 v250, v250, v252
    v_mul_f32 v251, v251, v253
    v_cvt_pk_bf16_f32 v250, v250, v251
    v_and_b32 v251, 0xffff0000, v250
    v_lshlrev_b32 v250, 16, v250
    v_add_f32 v250, v250, v251
    v_add_f32 v248, v248, v250
    v_lshlrev_b32 v250, 16, v242
    v_and_b32 v251, 0xffff0000, v242
    v_lshlrev_b32 v252, 16, v246
    v_and_b32 v253, 0xffff0000, v246
    v_mul_f32 v250, v250, v252
    v_mul_f32 v251, v251, v253
    v_cvt_pk_bf16_f32 v250, v250, v251
    v_and_b32 v251, 0xffff0000, v250
    v_lshlrev_b32 v250, 16, v250
    v_add_f32 v250, v250, v251
    v_add_f32 v248, v248, v250
    v_lshlrev_b32 v250, 16, v243
    v_and_b32 v251, 0xffff0000, v243
    v_lshlrev_b32 v252, 16, v247
    v_and_b32 v253, 0xffff0000, v247
    v_mul_f32 v250, v250, v252
    v_mul_f32 v251, v251, v253
    v_cvt_pk_bf16_f32 v250, v250, v251
    v_and_b32 v251, 0xffff0000, v250
    v_lshlrev_b32 v250, 16, v250
    v_add_f32 v250, v250, v251
    v_add_f32 v248, v248, v250
    s_nop 1
    v_add_f32_dpp v248, v248, v248 row_shr:1 row_mask:0xf bank_mask:0xf bound_ctrl:0
    s_nop 1
    v_add_f32_dpp v248, v248, v248 row_shr:2 row_mask:0xf bank_mask:0xf bound_ctrl:0
    s_nop 1
    v_add_f32_dpp v248, v248, v248 row_shr:4 row_mask:0xf bank_mask:0xf bound_ctrl:0
    s_nop 1
    v_add_f32_dpp v248, v248, v248 row_shr:8 row_mask:0xf bank_mask:0xf bound_ctrl:0
    s_nop 1
    v_add_f32_dpp v248, v248, v248 row_bcast:15 row_mask:0xa bank_mask:0xf
    s_nop 1
    v_add_f32_dpp v248, v248, v248 row_bcast:31 row_mask:0xc bank_mask:0xf
    v_cvt_pk_bf16_f32 v248, v248, v248
    v_and_b32 v248, 0xffff0000, v248
    v_mul_f32 v248, 0xbfb8aa3b, v248
    v_exp_f32 v248, v248
    s_nop 0
    v_add_f32 v248, 1.0, v248
    v_rcp_f32 v248, v248
    s_nop 0
    v_cvt_pk_bf16_f32 v248, v248, v248
    v_and_b32 v252, 0xffff0000, v248
    v_sub_f32 v248, 1.0, v252
    v_cvt_pk_bf16_f32 v248, v248, v248
    v_and_b32 v253, 0xffff0000, v248
    v_mov_b32 v30, v252
    v_mov_b32 v31, v253
    s_mov_b32 s28, s14
    s_mov_b32 s29, s15
    s_mov_b32 s30, 0x1100000
    s_mov_b32 s31, 0x20000
    s_lshl_b32 s39, s18, 7
    s_add_u32 s60, s60, s39
    s_lshl_b32 s60, s60, 3
    s_add_u32 s60, s60, 0x1000000
    v_mov_b32 v29, 0
    s_waitcnt vmcnt(4)
    s_barrier
    s_waitcnt lgkmcnt(0)
    ds_read_b128 v[128:131], v2 offset:0
    ds_read_b64_tr_b16 v[32:33], v5 offset:0
    ds_read_b64_tr_b16 v[34:35], v5 offset:512
    ds_read_b64_tr_b16 v[36:37], v6 offset:0
    ds_read_b64_tr_b16 v[38:39], v6 offset:512
    ds_read_b64_tr_b16 v[40:41], v5 offset:8192
    ds_read_b64_tr_b16 v[42:43], v5 offset:8704
    ds_read_b64_tr_b16 v[44:45], v6 offset:8192
    ds_read_b64_tr_b16 v[46:47], v6 offset:8704
    ds_read_b128 v[132:135], v2 offset:2048
    s_waitcnt lgkmcnt(5)
    v_mfma_f32_16x16x32_bf16 v[64:67], v[32:35], v[128:131], 0
    v_xor_b32 v3, 64, v2
    ds_read_b128 v[136:139], v3 offset:0
    ds_read_b64_tr_b16 v[48:49], v5 offset:4096
    ds_read_b64_tr_b16 v[50:51], v5 offset:4608
    v_mfma_f32_16x16x32_bf16 v[72:75], v[36:39], v[128:131], 0
    ds_read_b64_tr_b16 v[52:53], v6 offset:4096
    ds_read_b64_tr_b16 v[54:55], v6 offset:4608
    s_add_u32 m0, s56, 0x10000
    s_add_u32 s48, s50, 2
    s_waitcnt lgkmcnt(6)
    v_mfma_f32_16x16x32_bf16 v[80:83], v[128:131], v[40:43], 0
    s_and_b32 s48, s48, 7
    s_mul_i32 s49, s48, 196608
    s_lshl_b32 s48, s48, 7
    buffer_load_dwordx4 v11, s[20:23], s48 offen offset:0 lds
    v_mfma_f32_16x16x32_bf16 v[84:87], v[128:131], v[44:47], 0
    buffer_load_dwordx4 v12, s[20:23], s48 offen offset:1024 lds
    s_waitcnt lgkmcnt(5)
    v_mfma_f32_16x16x32_bf16 v[68:71], v[32:35], v[132:135], 0
    ds_read_b64_tr_b16 v[56:57], v5 offset:12288
    ds_read_b64_tr_b16 v[58:59], v5 offset:12800
    ds_read_b64_tr_b16 v[60:61], v6 offset:12288
    v_mfma_f32_16x16x32_bf16 v[76:79], v[36:39], v[132:135], 0
    ds_read_b64_tr_b16 v[62:63], v6 offset:12800
    ds_read_b128 v[140:143], v3 offset:2048
    s_add_u32 m0, s57, 0x14000
    v_mfma_f32_16x16x32_bf16 v[88:91], v[132:135], v[40:43], 0
    s_nop 0
    buffer_load_dwordx4 v13, s[24:27], s49 offen offset:0 lds
    s_add_u32 m0, s57, 0x16000
    v_mfma_f32_16x16x32_bf16 v[92:95], v[132:135], v[44:47], 0
    s_add_u32 s49, s49, s51
    buffer_load_dwordx4 v13, s[24:27], s49 offen offset:0 lds
    s_waitcnt lgkmcnt(5)
    v_mfma_f32_16x16x32_bf16 v[64:67], v[48:51], v[136:139], v[64:67]
    s_waitcnt vmcnt(4)
    s_barrier
    v_add_u32 v2, 0x8000, v2
    v_add_u32 v5, 0x8000, v5
    v_add_u32 v6, 0x8000, v6
    ds_read_b128 v[144:147], v2 offset:0
    v_mfma_f32_16x16x32_bf16 v[72:75], v[52:55], v[136:139], v[72:75]
    ds_read_b64_tr_b16 v[32:33], v5 offset:0
    ds_read_b64_tr_b16 v[34:35], v5 offset:512
    ds_read_b64_tr_b16 v[36:37], v6 offset:0
    ds_read_b64_tr_b16 v[38:39], v6 offset:512
    s_waitcnt lgkmcnt(6)
    v_mfma_f32_16x16x32_bf16 v[80:83], v[136:139], v[56:59], v[80:83]
    s_add_u32 m0, s56, 0x18000
    s_add_u32 s48, s50, 3
    s_and_b32 s48, s48, 7
    s_mul_i32 s49, s48, 196608
    v_mfma_f32_16x16x32_bf16 v[84:87], v[136:139], v[60:63], v[84:87]
    s_lshl_b32 s48, s48, 7
    buffer_load_dwordx4 v11, s[20:23], s48 offen offset:0 lds
    buffer_load_dwordx4 v12, s[20:23], s48 offen offset:1024 lds
    s_waitcnt lgkmcnt(5)
    v_mfma_f32_16x16x32_bf16 v[68:71], v[48:51], v[140:143], v[68:71]
    ds_read_b64_tr_b16 v[40:41], v5 offset:8192
    ds_read_b64_tr_b16 v[42:43], v5 offset:8704
    ds_read_b64_tr_b16 v[44:45], v6 offset:8192
    v_mfma_f32_16x16x32_bf16 v[76:79], v[52:55], v[140:143], v[76:79]
    ds_read_b64_tr_b16 v[46:47], v6 offset:8704
    ds_read_b128 v[148:151], v2 offset:2048
    s_add_u32 m0, s57, 0x1c000
    v_mfma_f32_16x16x32_bf16 v[88:91], v[140:143], v[56:59], v[88:91]
    s_nop 0
    buffer_load_dwordx4 v13, s[24:27], s49 offen offset:0 lds
    s_add_u32 m0, s57, 0x1e000
    v_mfma_f32_16x16x32_bf16 v[92:95], v[140:143], v[60:63], v[92:95]
    s_add_u32 s49, s49, s51
    buffer_load_dwordx4 v13, s[24:27], s49 offen offset:0 lds
    s_waitcnt lgkmcnt(5)
    v_mfma_f32_16x16x32_bf16 v[64:67], v[32:35], v[144:147], v[64:67]
    v_xor_b32 v3, 64, v2
    ds_read_b128 v[152:155], v3 offset:0
    ds_read_b64_tr_b16 v[48:49], v5 offset:4096
    ds_read_b64_tr_b16 v[50:51], v5 offset:4608
    v_mfma_f32_16x16x32_bf16 v[72:75], v[36:39], v[144:147], v[72:75]
    ds_read_b64_tr_b16 v[52:53], v6 offset:4096
    ds_read_b64_tr_b16 v[54:55], v6 offset:4608
    s_add_u32 m0, s56, 0x20000
    s_add_u32 s48, s50, 4
    s_waitcnt lgkmcnt(6)
    v_mfma_f32_16x16x32_bf16 v[80:83], v[144:147], v[40:43], v[80:83]
    s_and_b32 s48, s48, 7
    s_mul_i32 s49, s48, 196608
    s_lshl_b32 s48, s48, 7
    buffer_load_dwordx4 v11, s[20:23], s48 offen offset:0 lds
    v_mfma_f32_16x16x32_bf16 v[84:87], v[144:147], v[44:47], v[84:87]
    buffer_load_dwordx4 v12, s[20:23], s48 offen offset:1024 lds
    s_waitcnt lgkmcnt(5)
    v_mfma_f32_16x16x32_bf16 v[68:71], v[32:35], v[148:151], v[68:71]
    ds_read_b64_tr_b16 v[56:57], v5 offset:12288
    ds_read_b64_tr_b16 v[58:59], v5 offset:12800
    v_mfma_f32_16x16x32_bf16 v[76:79], v[36:39], v[148:151], v[76:79]
    ds_read_b64_tr_b16 v[60:61], v6 offset:12288
    ds_read_b64_tr_b16 v[62:63], v6 offset:12800
    v_mfma_f32_16x16x32_bf16 v[88:91], v[148:151], v[40:43], v[88:91]
    ds_read_b128 v[156:159], v3 offset:2048
    s_add_u32 m0, s57, 0x24000
    v_mfma_f32_16x16x32_bf16 v[92:95], v[148:151], v[44:47], v[92:95]
    s_nop 0
    buffer_load_dwordx4 v13, s[24:27], s49 offen offset:0 lds
    s_waitcnt lgkmcnt(5)
    v_mfma_f32_16x16x32_bf16 v[64:67], v[48:51], v[152:155], v[64:67]
    s_waitcnt vmcnt(7)
    s_barrier
    v_add_u32 v2, 0x8000, v2
    v_add_u32 v5, 0x8000, v5
    v_add_u32 v6, 0x8000, v6
    ds_read_b128 v[160:163], v2 offset:0
    ds_read_b64_tr_b16 v[32:33], v5 offset:0
    v_mfma_f32_16x16x32_bf16 v[72:75], v[52:55], v[152:155], v[72:75]
    ds_read_b64_tr_b16 v[34:35], v5 offset:512
    ds_read_b64_tr_b16 v[36:37], v6 offset:0
    ds_read_b64_tr_b16 v[38:39], v6 offset:512
    s_add_u32 m0, s57, 0x26000
    s_add_u32 s49, s49, s51
    s_waitcnt lgkmcnt(6)
    v_mfma_f32_16x16x32_bf16 v[80:83], v[152:155], v[56:59], v[80:83]
    buffer_load_dwordx4 v13, s[24:27], s49 offen offset:0 lds
    s_add_u32 m0, s56, 0x0
    s_add_u32 s48, s50, 5
    s_and_b32 s48, s48, 7
    s_mul_i32 s49, s48, 196608
    v_mfma_f32_16x16x32_bf16 v[84:87], v[152:155], v[60:63], v[84:87]
    s_lshl_b32 s48, s48, 7
    buffer_load_dwordx4 v11, s[20:23], s48 offen offset:0 lds
    s_waitcnt lgkmcnt(5)
    v_mfma_f32_16x16x32_bf16 v[68:71], v[48:51], v[156:159], v[68:71]
    ds_read_b64_tr_b16 v[40:41], v5 offset:8192
    ds_read_b64_tr_b16 v[42:43], v5 offset:8704
    v_mfma_f32_16x16x32_bf16 v[76:79], v[52:55], v[156:159], v[76:79]
    ds_read_b64_tr_b16 v[44:45], v6 offset:8192
    ds_read_b64_tr_b16 v[46:47], v6 offset:8704
    v_mfma_f32_16x16x32_bf16 v[88:91], v[156:159], v[56:59], v[88:91]
    ds_read_b128 v[164:167], v2 offset:2048
    buffer_load_dwordx4 v12, s[20:23], s48 offen offset:1024 lds
    v_mfma_f32_16x16x32_bf16 v[92:95], v[156:159], v[60:63], v[92:95]
    s_waitcnt lgkmcnt(5)
    v_mfma_f32_16x16x32_bf16 v[64:67], v[32:35], v[160:163], v[64:67]
    v_xor_b32 v3, 64, v2
    ds_read_b128 v[168:171], v3 offset:0
    ds_read_b64_tr_b16 v[48:49], v5 offset:4096
    v_mfma_f32_16x16x32_bf16 v[72:75], v[36:39], v[160:163], v[72:75]
    ds_read_b64_tr_b16 v[50:51], v5 offset:4608
    ds_read_b64_tr_b16 v[52:53], v6 offset:4096
    ds_read_b64_tr_b16 v[54:55], v6 offset:4608
    s_waitcnt lgkmcnt(6)
    v_mfma_f32_16x16x32_bf16 v[80:83], v[160:163], v[40:43], v[80:83]
    s_add_u32 m0, s57, 0x4000
    s_nop 0
    buffer_load_dwordx4 v13, s[24:27], s49 offen offset:0 lds
    v_mfma_f32_16x16x32_bf16 v[84:87], v[160:163], v[44:47], v[84:87]
    s_waitcnt lgkmcnt(5)
    v_mfma_f32_16x16x32_bf16 v[68:71], v[32:35], v[164:167], v[68:71]
    ds_read_b64_tr_b16 v[56:57], v5 offset:12288
    ds_read_b64_tr_b16 v[58:59], v5 offset:12800
    v_mfma_f32_16x16x32_bf16 v[76:79], v[36:39], v[164:167], v[76:79]
    ds_read_b64_tr_b16 v[60:61], v6 offset:12288
    ds_read_b64_tr_b16 v[62:63], v6 offset:12800
    v_mfma_f32_16x16x32_bf16 v[88:91], v[164:167], v[40:43], v[88:91]
    ds_read_b128 v[172:175], v3 offset:2048
    s_add_u32 m0, s57, 0x6000
    v_mfma_f32_16x16x32_bf16 v[92:95], v[164:167], v[44:47], v[92:95]
    s_add_u32 s49, s49, s51
    buffer_load_dwordx4 v13, s[24:27], s49 offen offset:0 lds
    s_waitcnt lgkmcnt(5)
    v_mfma_f32_16x16x32_bf16 v[64:67], v[48:51], v[168:171], v[64:67]
    s_waitcnt vmcnt(8)
    s_barrier
    v_add_u32 v2, 0x8000, v2
    v_add_u32 v5, 0x8000, v5
    v_add_u32 v6, 0x8000, v6
    ds_read_b128 v[176:179], v2 offset:0
    v_mfma_f32_16x16x32_bf16 v[72:75], v[52:55], v[168:171], v[72:75]
    ds_read_b64_tr_b16 v[32:33], v5 offset:0
    ds_read_b64_tr_b16 v[34:35], v5 offset:512
    ds_read_b64_tr_b16 v[36:37], v6 offset:0
    ds_read_b64_tr_b16 v[38:39], v6 offset:512
    s_waitcnt lgkmcnt(6)
    v_mfma_f32_16x16x32_bf16 v[80:83], v[168:171], v[56:59], v[80:83]
    s_add_u32 m0, s56, 0x8000
    s_add_u32 s48, s50, 6
    s_and_b32 s48, s48, 7
    s_mul_i32 s49, s48, 196608
    v_mfma_f32_16x16x32_bf16 v[84:87], v[168:171], v[60:63], v[84:87]
    s_lshl_b32 s48, s48, 7
    buffer_load_dwordx4 v11, s[20:23], s48 offen offset:0 lds
    buffer_load_dwordx4 v12, s[20:23], s48 offen offset:1024 lds
    s_waitcnt lgkmcnt(5)
    v_mfma_f32_16x16x32_bf16 v[68:71], v[48:51], v[172:175], v[68:71]
    ds_read_b64_tr_b16 v[40:41], v5 offset:8192
    ds_read_b64_tr_b16 v[42:43], v5 offset:8704
    v_mfma_f32_16x16x32_bf16 v[76:79], v[52:55], v[172:175], v[76:79]
    ds_read_b64_tr_b16 v[44:45], v6 offset:8192
    ds_read_b64_tr_b16 v[46:47], v6 offset:8704
    v_mfma_f32_16x16x32_bf16 v[88:91], v[172:175], v[56:59], v[88:91]
    ds_read_b128 v[180:183], v2 offset:2048
    s_add_u32 m0, s57, 0xc000
    v_mfma_f32_16x16x32_bf16 v[92:95], v[172:175], v[60:63], v[92:95]
    s_nop 0
    buffer_load_dwordx4 v13, s[24:27], s49 offen offset:0 lds
    s_waitcnt lgkmcnt(5)
    v_mfma_f32_16x16x32_bf16 v[64:67], v[32:35], v[176:179], v[64:67]
    v_xor_b32 v3, 64, v2
    ds_read_b128 v[184:187], v3 offset:0
    ds_read_b64_tr_b16 v[48:49], v5 offset:4096
    v_mfma_f32_16x16x32_bf16 v[72:75], v[36:39], v[176:179], v[72:75]
    ds_read_b64_tr_b16 v[50:51], v5 offset:4608
    ds_read_b64_tr_b16 v[52:53], v6 offset:4096
    ds_read_b64_tr_b16 v[54:55], v6 offset:4608
    s_waitcnt lgkmcnt(6)
    v_mfma_f32_16x16x32_bf16 v[80:83], v[176:179], v[40:43], v[80:83]
    s_add_u32 m0, s57, 0xe000
    s_add_u32 s49, s49, s51
    buffer_load_dwordx4 v13, s[24:27], s49 offen offset:0 lds
    v_mfma_f32_16x16x32_bf16 v[84:87], v[176:179], v[44:47], v[84:87]
    s_waitcnt lgkmcnt(5)
    v_mfma_f32_16x16x32_bf16 v[68:71], v[32:35], v[180:183], v[68:71]
    ds_read_b64_tr_b16 v[56:57], v5 offset:12288
    ds_read_b64_tr_b16 v[58:59], v5 offset:12800
    v_mfma_f32_16x16x32_bf16 v[76:79], v[36:39], v[180:183], v[76:79]
    ds_read_b64_tr_b16 v[60:61], v6 offset:12288
    ds_read_b64_tr_b16 v[62:63], v6 offset:12800
    v_mfma_f32_16x16x32_bf16 v[88:91], v[180:183], v[40:43], v[88:91]
    ds_read_b128 v[188:191], v3 offset:2048
    v_mfma_f32_16x16x32_bf16 v[92:95], v[180:183], v[44:47], v[92:95]
    s_waitcnt lgkmcnt(5)
    v_mfma_f32_16x16x32_bf16 v[64:67], v[48:51], v[184:187], v[64:67]
    s_waitcnt vmcnt(8)
    s_barrier
    v_add_u32 v2, 0x8000, v2
    v_add_u32 v5, 0x8000, v5
    v_add_u32 v6, 0x8000, v6
    ds_read_b128 v[192:195], v2 offset:0
    v_mfma_f32_16x16x32_bf16 v[72:75], v[52:55], v[184:187], v[72:75]
    ds_read_b64_tr_b16 v[32:33], v5 offset:0
    ds_read_b64_tr_b16 v[34:35], v5 offset:512
    ds_read_b64_tr_b16 v[36:37], v6 offset:0
    ds_read_b64_tr_b16 v[38:39], v6 offset:512
    s_waitcnt lgkmcnt(6)
    v_mfma_f32_16x16x32_bf16 v[80:83], v[184:187], v[56:59], v[80:83]
    s_add_u32 m0, s56, 0x10000
    s_add_u32 s48, s50, 7
    s_and_b32 s48, s48, 7
    s_mul_i32 s49, s48, 196608
    v_mfma_f32_16x16x32_bf16 v[84:87], v[184:187], v[60:63], v[84:87]
    s_lshl_b32 s48, s48, 7
    buffer_load_dwordx4 v11, s[20:23], s48 offen offset:0 lds
    buffer_load_dwordx4 v12, s[20:23], s48 offen offset:1024 lds
    s_waitcnt lgkmcnt(5)
    v_mfma_f32_16x16x32_bf16 v[68:71], v[48:51], v[188:191], v[68:71]
    ds_read_b64_tr_b16 v[40:41], v5 offset:8192
    ds_read_b64_tr_b16 v[42:43], v5 offset:8704
    v_mfma_f32_16x16x32_bf16 v[76:79], v[52:55], v[188:191], v[76:79]
    ds_read_b64_tr_b16 v[44:45], v6 offset:8192
    ds_read_b64_tr_b16 v[46:47], v6 offset:8704
    v_mfma_f32_16x16x32_bf16 v[88:91], v[188:191], v[56:59], v[88:91]
    ds_read_b128 v[196:199], v2 offset:2048
    s_add_u32 m0, s57, 0x14000
    v_mfma_f32_16x16x32_bf16 v[92:95], v[188:191], v[60:63], v[92:95]
    s_nop 0
    buffer_load_dwordx4 v13, s[24:27], s49 offen offset:0 lds
    s_waitcnt lgkmcnt(5)
    v_mfma_f32_16x16x32_bf16 v[64:67], v[32:35], v[192:195], v[64:67]
    v_xor_b32 v3, 64, v2
    ds_read_b128 v[200:203], v3 offset:0
    ds_read_b64_tr_b16 v[48:49], v5 offset:4096
    v_mfma_f32_16x16x32_bf16 v[72:75], v[36:39], v[192:195], v[72:75]
    ds_read_b64_tr_b16 v[50:51], v5 offset:4608
    ds_read_b64_tr_b16 v[52:53], v6 offset:4096
    ds_read_b64_tr_b16 v[54:55], v6 offset:4608
    s_waitcnt lgkmcnt(6)
    v_mfma_f32_16x16x32_bf16 v[80:83], v[192:195], v[40:43], v[80:83]
    s_add_u32 m0, s57, 0x16000
    s_add_u32 s49, s49, s51
    buffer_load_dwordx4 v13, s[24:27], s49 offen offset:0 lds
    v_mfma_f32_16x16x32_bf16 v[84:87], v[192:195], v[44:47], v[84:87]
    s_waitcnt lgkmcnt(5)
    v_mfma_f32_16x16x32_bf16 v[68:71], v[32:35], v[196:199], v[68:71]
    ds_read_b64_tr_b16 v[56:57], v5 offset:12288
    ds_read_b64_tr_b16 v[58:59], v5 offset:12800
    v_mfma_f32_16x16x32_bf16 v[76:79], v[36:39], v[196:199], v[76:79]
    ds_read_b64_tr_b16 v[60:61], v6 offset:12288
    ds_read_b64_tr_b16 v[62:63], v6 offset:12800
    v_mfma_f32_16x16x32_bf16 v[88:91], v[196:199], v[40:43], v[88:91]
    ds_read_b128 v[204:207], v3 offset:2048
    v_mfma_f32_16x16x32_bf16 v[92:95], v[196:199], v[44:47], v[92:95]
    s_waitcnt lgkmcnt(5)
    v_mfma_f32_16x16x32_bf16 v[64:67], v[48:51], v[200:203], v[64:67]
    s_waitcnt vmcnt(8)
    s_barrier
    v_add_u32 v2, 0xfffe0000, v2
    v_add_u32 v5, 0xfffe0000, v5
    v_add_u32 v6, 0xfffe0000, v6
    ds_read_b128 v[208:211], v2 offset:0
    v_mfma_f32_16x16x32_bf16 v[72:75], v[52:55], v[200:203], v[72:75]
    ds_read_b64_tr_b16 v[32:33], v5 offset:0
    ds_read_b64_tr_b16 v[34:35], v5 offset:512
    ds_read_b64_tr_b16 v[36:37], v6 offset:0
    ds_read_b64_tr_b16 v[38:39], v6 offset:512
    s_waitcnt lgkmcnt(6)
    v_mfma_f32_16x16x32_bf16 v[80:83], v[200:203], v[56:59], v[80:83]
    s_add_u32 m0, s57, 0x18000
    s_add_u32 s48, s50, 0
    s_and_b32 s48, s48, 7
    s_mul_i32 s49, s48, 229376
    v_mfma_f32_16x16x32_bf16 v[84:87], v[200:203], v[60:63], v[84:87]
    s_add_u32 s49, s49, s52
    buffer_load_dwordx4 v16, s[4:7], s49 offen offset:0 lds
    s_waitcnt lgkmcnt(5)
    v_mfma_f32_16x16x32_bf16 v[68:71], v[48:51], v[204:207], v[68:71]
    ds_read_b64_tr_b16 v[40:41], v5 offset:8192
    ds_read_b64_tr_b16 v[42:43], v5 offset:8704
    ds_read_b64_tr_b16 v[44:45], v6 offset:8192
    v_mfma_f32_16x16x32_bf16 v[76:79], v[52:55], v[204:207], v[76:79]
    ds_read_b64_tr_b16 v[46:47], v6 offset:8704
    ds_read_b128 v[212:215], v2 offset:2048
    s_add_u32 m0, s57, 0x1a000
    v_mfma_f32_16x16x32_bf16 v[88:91], v[204:207], v[56:59], v[88:91]
    s_add_u32 s48, s50, 1
    s_and_b32 s48, s48, 7
    s_mul_i32 s49, s48, 229376
    v_mfma_f32_16x16x32_bf16 v[92:95], v[204:207], v[60:63], v[92:95]
    s_add_u32 s49, s49, s52
    buffer_load_dwordx4 v16, s[4:7], s49 offen offset:0 lds
    s_waitcnt lgkmcnt(5)
    v_mfma_f32_16x16x32_bf16 v[64:67], v[32:35], v[208:211], v[64:67]
    v_xor_b32 v3, 64, v2
    ds_read_b128 v[216:219], v3 offset:0
    v_mfma_f32_16x16x32_bf16 v[72:75], v[36:39], v[208:211], v[72:75]
    ds_read_b64_tr_b16 v[48:49], v5 offset:4096
    ds_read_b64_tr_b16 v[50:51], v5 offset:4608
    s_waitcnt lgkmcnt(4)
    v_mfma_f32_16x16x32_bf16 v[80:83], v[208:211], v[40:43], v[80:83]
    ds_read_b64_tr_b16 v[52:53], v6 offset:4096
    ds_read_b64_tr_b16 v[54:55], v6 offset:4608
    v_mfma_f32_16x16x32_bf16 v[84:87], v[208:211], v[44:47], v[84:87]
    s_waitcnt lgkmcnt(5)
    v_mfma_f32_16x16x32_bf16 v[68:71], v[32:35], v[212:215], v[68:71]
    ds_read_b64_tr_b16 v[56:57], v5 offset:12288
    ds_read_b64_tr_b16 v[58:59], v5 offset:12800
    v_mfma_f32_16x16x32_bf16 v[76:79], v[36:39], v[212:215], v[76:79]
    ds_read_b64_tr_b16 v[60:61], v6 offset:12288
    ds_read_b64_tr_b16 v[62:63], v6 offset:12800
    v_mfma_f32_16x16x32_bf16 v[88:91], v[212:215], v[40:43], v[88:91]
    ds_read_b128 v[220:223], v3 offset:2048
    v_mfma_f32_16x16x32_bf16 v[92:95], v[212:215], v[44:47], v[92:95]
    s_waitcnt lgkmcnt(5)
    v_mfma_f32_16x16x32_bf16 v[64:67], v[48:51], v[216:219], v[64:67]
    s_waitcnt vmcnt(6)
    s_barrier
    v_add_u32 v2, 0x8000, v2
    v_add_u32 v5, 0x8000, v5
    v_mfma_f32_16x16x32_bf16 v[72:75], v[52:55], v[216:219], v[72:75]
    v_add_u32 v6, 0x8000, v6
    ds_read_b128 v[224:227], v2 offset:0
    s_waitcnt lgkmcnt(2)
    v_mfma_f32_16x16x32_bf16 v[80:83], v[216:219], v[56:59], v[80:83]
    ds_read_b64_tr_b16 v[32:33], v5 offset:0
    ds_read_b64_tr_b16 v[34:35], v5 offset:512
    v_mfma_f32_16x16x32_bf16 v[84:87], v[216:219], v[60:63], v[84:87]
    ds_read_b64_tr_b16 v[36:37], v6 offset:0
    ds_read_b64_tr_b16 v[38:39], v6 offset:512
    s_waitcnt lgkmcnt(5)
    v_mfma_f32_16x16x32_bf16 v[68:71], v[48:51], v[220:223], v[68:71]
    ds_read_b64_tr_b16 v[40:41], v5 offset:8192
    ds_read_b64_tr_b16 v[42:43], v5 offset:8704
    v_mfma_f32_16x16x32_bf16 v[76:79], v[52:55], v[220:223], v[76:79]
    ds_read_b64_tr_b16 v[44:45], v6 offset:8192
    ds_read_b64_tr_b16 v[46:47], v6 offset:8704
    v_mfma_f32_16x16x32_bf16 v[88:91], v[220:223], v[56:59], v[88:91]
    ds_read_b128 v[228:231], v2 offset:2048
    v_mfma_f32_16x16x32_bf16 v[92:95], v[220:223], v[60:63], v[92:95]
    s_waitcnt lgkmcnt(5)
    v_mfma_f32_16x16x32_bf16 v[64:67], v[32:35], v[224:227], v[64:67]
    v_xor_b32 v3, 64, v2
    ds_read_b128 v[232:235], v3 offset:0
    v_mfma_f32_16x16x32_bf16 v[72:75], v[36:39], v[224:227], v[72:75]
    ds_read_b64_tr_b16 v[48:49], v5 offset:4096
    ds_read_b64_tr_b16 v[50:51], v5 offset:4608
    s_waitcnt lgkmcnt(4)
    v_mfma_f32_16x16x32_bf16 v[80:83], v[224:227], v[40:43], v[80:83]
    ds_read_b64_tr_b16 v[52:53], v6 offset:4096
    ds_read_b64_tr_b16 v[54:55], v6 offset:4608
    v_mfma_f32_16x16x32_bf16 v[84:87], v[224:227], v[44:47], v[84:87]
    s_waitcnt lgkmcnt(5)
    v_mfma_f32_16x16x32_bf16 v[68:71], v[32:35], v[228:231], v[68:71]
    ds_read_b64_tr_b16 v[56:57], v5 offset:12288
    ds_read_b64_tr_b16 v[58:59], v5 offset:12800
    v_mfma_f32_16x16x32_bf16 v[76:79], v[36:39], v[228:231], v[76:79]
    ds_read_b64_tr_b16 v[60:61], v6 offset:12288
    ds_read_b64_tr_b16 v[62:63], v6 offset:12800
    v_mfma_f32_16x16x32_bf16 v[88:91], v[228:231], v[40:43], v[88:91]
    ds_read_b128 v[236:239], v3 offset:2048
    v_mfma_f32_16x16x32_bf16 v[92:95], v[228:231], v[44:47], v[92:95]
    s_waitcnt lgkmcnt(5)
    v_mfma_f32_16x16x32_bf16 v[64:67], v[48:51], v[232:235], v[64:67]
    s_waitcnt vmcnt(2)
    s_barrier
    v_add_u32 v2, 0x8000, v2
    v_add_u32 v5, 0x8000, v5
    v_add_u32 v6, 0x8000, v6
    ds_read_b128 v[240:243], v2 offset:0
    v_mfma_f32_16x16x32_bf16 v[72:75], v[52:55], v[232:235], v[72:75]
    ds_read_b64_tr_b16 v[32:33], v5 offset:0
    ds_read_b64_tr_b16 v[34:35], v5 offset:512
    ds_read_b64_tr_b16 v[36:37], v6 offset:0
    ds_read_b64_tr_b16 v[38:39], v6 offset:512
    s_waitcnt lgkmcnt(6)
    v_mfma_f32_16x16x32_bf16 v[80:83], v[232:235], v[56:59], v[80:83]
    s_add_u32 m0, s57, 0x20000
    s_add_u32 s48, s50, 2
    s_and_b32 s48, s48, 7
    s_mul_i32 s49, s48, 229376
    v_mfma_f32_16x16x32_bf16 v[84:87], v[232:235], v[60:63], v[84:87]
    s_add_u32 s49, s49, s52
    buffer_load_dwordx4 v16, s[4:7], s49 offen offset:0 lds
    s_waitcnt lgkmcnt(5)
    v_mfma_f32_16x16x32_bf16 v[68:71], v[48:51], v[236:239], v[68:71]
    ds_read_b64_tr_b16 v[40:41], v5 offset:8192
    ds_read_b64_tr_b16 v[42:43], v5 offset:8704
    ds_read_b64_tr_b16 v[44:45], v6 offset:8192
    v_mfma_f32_16x16x32_bf16 v[76:79], v[52:55], v[236:239], v[76:79]
    ds_read_b64_tr_b16 v[46:47], v6 offset:8704
    ds_read_b128 v[244:247], v2 offset:2048
    s_add_u32 m0, s57, 0x22000
    v_mfma_f32_16x16x32_bf16 v[88:91], v[236:239], v[56:59], v[88:91]
    s_add_u32 s48, s50, 3
    s_and_b32 s48, s48, 7
    s_mul_i32 s49, s48, 229376
    v_mfma_f32_16x16x32_bf16 v[92:95], v[236:239], v[60:63], v[92:95]
    s_add_u32 s49, s49, s52
    buffer_load_dwordx4 v16, s[4:7], s49 offen offset:0 lds
    s_waitcnt lgkmcnt(5)
    v_mfma_f32_16x16x32_bf16 v[64:67], v[32:35], v[240:243], v[64:67]
    v_xor_b32 v3, 64, v2
    ds_read_b128 v[248:251], v3 offset:0
    v_mfma_f32_16x16x32_bf16 v[72:75], v[36:39], v[240:243], v[72:75]
    ds_read_b64_tr_b16 v[48:49], v5 offset:4096
    ds_read_b64_tr_b16 v[50:51], v5 offset:4608
    s_waitcnt lgkmcnt(4)
    v_mfma_f32_16x16x32_bf16 v[80:83], v[240:243], v[40:43], v[80:83]
    ds_read_b64_tr_b16 v[52:53], v6 offset:4096
    ds_read_b64_tr_b16 v[54:55], v6 offset:4608
    v_mfma_f32_16x16x32_bf16 v[84:87], v[240:243], v[44:47], v[84:87]
    s_waitcnt lgkmcnt(5)
    v_mfma_f32_16x16x32_bf16 v[68:71], v[32:35], v[244:247], v[68:71]
    ds_read_b64_tr_b16 v[56:57], v5 offset:12288
    ds_read_b64_tr_b16 v[58:59], v5 offset:12800
    v_mfma_f32_16x16x32_bf16 v[76:79], v[36:39], v[244:247], v[76:79]
    ds_read_b64_tr_b16 v[60:61], v6 offset:12288
    ds_read_b64_tr_b16 v[62:63], v6 offset:12800
    v_mfma_f32_16x16x32_bf16 v[88:91], v[244:247], v[40:43], v[88:91]
    ds_read_b128 v[252:255], v3 offset:2048
    v_mfma_f32_16x16x32_bf16 v[92:95], v[244:247], v[44:47], v[92:95]
    s_waitcnt lgkmcnt(5)
    v_mfma_f32_16x16x32_bf16 v[64:67], v[48:51], v[248:251], v[64:67]
    s_waitcnt vmcnt(2)
    s_barrier
    ds_read_b64_tr_b16 v[32:33], v9 offset:0
    ds_read_b64_tr_b16 v[34:35], v9 offset:256
    ds_read_b64_tr_b16 v[36:37], v9 offset:4096
    ds_read_b64_tr_b16 v[38:39], v9 offset:4352
    v_mfma_f32_16x16x32_bf16 v[72:75], v[52:55], v[248:251], v[72:75]
    ds_read_b64_tr_b16 v[40:41], v9 offset:2048
    ds_read_b64_tr_b16 v[42:43], v9 offset:2304
    ds_read_b64_tr_b16 v[44:45], v9 offset:6144
    ds_read_b64_tr_b16 v[46:47], v9 offset:6400
    s_waitcnt lgkmcnt(9)
    v_mfma_f32_16x16x32_bf16 v[80:83], v[248:251], v[56:59], v[80:83]
    s_add_u32 m0, s57, 0x0
    s_add_u32 s48, s50, 4
    s_and_b32 s48, s48, 7
    s_mul_i32 s49, s48, 229376
    v_mfma_f32_16x16x32_bf16 v[84:87], v[248:251], v[60:63], v[84:87]
    s_add_u32 s49, s49, s52
    buffer_load_dwordx4 v16, s[4:7], s49 offen offset:0 lds
    s_waitcnt lgkmcnt(8)
    v_mfma_f32_16x16x32_bf16 v[68:71], v[48:51], v[252:255], v[68:71]
    s_add_u32 m0, s57, 0x2000
    s_add_u32 s48, s50, 5
    v_mfma_f32_16x16x32_bf16 v[76:79], v[52:55], v[252:255], v[76:79]
    s_and_b32 s48, s48, 7
    s_mul_i32 s49, s48, 229376
    v_mfma_f32_16x16x32_bf16 v[88:91], v[252:255], v[56:59], v[88:91]
    s_add_u32 s49, s49, s52
    buffer_load_dwordx4 v16, s[4:7], s49 offen offset:0 lds
    v_mfma_f32_16x16x32_bf16 v[92:95], v[252:255], v[60:63], v[92:95]
    s_waitcnt lgkmcnt(4)
    v_mfma_f32_16x16x32_bf16 v[96:99], v[32:35], v[128:131], 0
    ds_read_b64_tr_b16 v[48:49], v9 offset:8192
    ds_read_b64_tr_b16 v[50:51], v9 offset:8448
    v_mfma_f32_16x16x32_bf16 v[104:107], v[36:39], v[128:131], 0
    ds_read_b64_tr_b16 v[52:53], v9 offset:12288
    ds_read_b64_tr_b16 v[54:55], v9 offset:12544
    v_mfma_f32_16x16x32_bf16 v[100:103], v[32:35], v[132:135], 0
    v_mov_b32 v112, -1
    v_mov_b32 v113, -1
    v_mov_b32 v114, -1
    v_mov_b32 v115, -1
    buffer_store_dwordx4 v[112:115], v1, s[28:31], s53 offen sc1
    s_add_u32 s53, s59, 32768
    s_mov_b64 exec, 1
    buffer_store_dword v29, v22, s[80:83], s59 offen sc1
    buffer_store_dword v29, v22, s[80:83], s53 offen sc1
    buffer_store_dword v29, v22, s[80:83], s90 offen sc1
    s_mov_b64 exec, -1
    v_mfma_f32_16x16x32_bf16 v[108:111], v[36:39], v[132:135], 0
    s_waitcnt lgkmcnt(4)
    v_mfma_f32_16x16x32_bf16 v[96:99], v[40:43], v[136:139], v[96:99]
    ds_read_b64_tr_b16 v[32:33], v9 offset:10240
    ds_read_b64_tr_b16 v[34:35], v9 offset:10496
    ds_read_b64_tr_b16 v[36:37], v9 offset:14336
    ds_read_b64_tr_b16 v[38:39], v9 offset:14592
    s_mov_b32 exec_lo, 0
    s_mov_b32 exec_hi, 0x80000000
    buffer_store_dwordx2 v[30:31], v29, s[28:31], s60 offen sc1
    s_mov_b64 exec, -1
    v_mfma_f32_16x16x32_bf16 v[104:107], v[44:47], v[136:139], v[104:107]
    v_cvt_pk_bf16_f32 v80, v80, v81
    v_cvt_pk_bf16_f32 v81, v82, v83
    v_cvt_pk_bf16_f32 v82, v84, v85
    v_cvt_pk_bf16_f32 v83, v86, v87
    v_mfma_f32_16x16x32_bf16 v[100:103], v[40:43], v[140:143], v[100:103]
    v_cvt_pk_bf16_f32 v84, v88, v89
    v_cvt_pk_bf16_f32 v85, v90, v91
    v_mfma_f32_16x16x32_bf16 v[108:111], v[44:47], v[140:143], v[108:111]
    v_cvt_pk_bf16_f32 v86, v92, v93
    v_cvt_pk_bf16_f32 v87, v94, v95
    s_waitcnt lgkmcnt(4)
    v_mfma_f32_16x16x32_bf16 v[96:99], v[48:51], v[144:147], v[96:99]
    s_waitcnt vmcnt(7)
    s_barrier
    v_add_u32 v9, 0x8000, v9
    ds_read_b64_tr_b16 v[40:41], v9 offset:0
    ds_read_b64_tr_b16 v[42:43], v9 offset:256
    ds_read_b64_tr_b16 v[44:45], v9 offset:4096
    ds_read_b64_tr_b16 v[46:47], v9 offset:4352
    s_add_u32 m0, s57, 0x8000
    s_add_u32 s48, s50, 6
    s_and_b32 s48, s48, 7
    v_mfma_f32_16x16x32_bf16 v[104:107], v[52:55], v[144:147], v[104:107]
    s_mul_i32 s49, s48, 229376
    s_add_u32 s49, s49, s52
    buffer_load_dwordx4 v16, s[4:7], s49 offen offset:0 lds
    v_permlane16_swap_b32 v80, v82
    v_permlane16_swap_b32 v81, v83
    v_permlane16_swap_b32 v84, v86
    v_permlane16_swap_b32 v85, v87
    v_mfma_f32_16x16x32_bf16 v[100:103], v[48:51], v[148:151], v[100:103]
    v_mul_f32 v64, s92, v64
    v_mfma_f32_16x16x32_bf16 v[108:111], v[52:55], v[148:151], v[108:111]
    v_mul_f32 v65, s92, v65
    s_waitcnt lgkmcnt(4)
    v_mfma_f32_16x16x32_bf16 v[96:99], v[32:35], v[152:155], v[96:99]
    ds_read_b64_tr_b16 v[48:49], v9 offset:2048
    ds_read_b64_tr_b16 v[50:51], v9 offset:2304
    ds_read_b64_tr_b16 v[52:53], v9 offset:6144
    ds_read_b64_tr_b16 v[54:55], v9 offset:6400
    s_add_u32 m0, s57, 0xa000
    s_add_u32 s48, s50, 7
    s_and_b32 s48, s48, 7
    s_mul_i32 s49, s48, 229376
    v_mfma_f32_16x16x32_bf16 v[104:107], v[36:39], v[152:155], v[104:107]
    s_add_u32 s49, s49, s52
    buffer_load_dwordx4 v16, s[4:7], s49 offen offset:0 lds
    buffer_store_dwordx4 v[80:83], v10, s[28:31], s96 offen offset:0 sc1
    v_mul_f32 v66, s92, v66
    v_mul_f32 v67, s92, v67
    v_mul_f32 v68, s92, v68
    v_mul_f32 v69, s92, v69
    v_mfma_f32_16x16x32_bf16 v[100:103], v[32:35], v[156:159], v[100:103]
    buffer_store_dwordx4 v[84:87], v10, s[28:31], s96 offen offset:512 sc1
    v_mul_f32 v70, s92, v70
    v_mul_f32 v71, s92, v71
    v_mfma_f32_16x16x32_bf16 v[108:111], v[36:39], v[156:159], v[108:111]
    v_mul_f32 v72, s92, v72
    v_mul_f32 v73, s92, v73
    s_waitcnt lgkmcnt(4)
    v_mfma_f32_16x16x32_bf16 v[96:99], v[40:43], v[160:163], v[96:99]
    ds_read_b64_tr_b16 v[32:33], v9 offset:8192
    ds_read_b64_tr_b16 v[34:35], v9 offset:8448
    ds_read_b64_tr_b16 v[36:37], v9 offset:12288
    ds_read_b64_tr_b16 v[38:39], v9 offset:12544
    v_mfma_f32_16x16x32_bf16 v[104:107], v[44:47], v[160:163], v[104:107]
    v_mul_f32 v74, s92, v74
    v_mul_f32 v75, s92, v75
    v_mul_f32 v76, s92, v76
    v_mul_f32 v77, s92, v77
    v_mfma_f32_16x16x32_bf16 v[100:103], v[40:43], v[164:167], v[100:103]
    v_mul_f32 v78, s92, v78
    v_mul_f32 v79, s92, v79
    v_mfma_f32_16x16x32_bf16 v[108:111], v[44:47], v[164:167], v[108:111]
    v_cvt_pk_bf16_f32 v64, v64, v65
    v_cvt_pk_bf16_f32 v65, v66, v67
    s_waitcnt lgkmcnt(4)
    v_mfma_f32_16x16x32_bf16 v[96:99], v[48:51], v[168:171], v[96:99]
    ds_read_b64_tr_b16 v[40:41], v9 offset:10240
    ds_read_b64_tr_b16 v[42:43], v9 offset:10496
    ds_read_b64_tr_b16 v[44:45], v9 offset:14336
    ds_read_b64_tr_b16 v[46:47], v9 offset:14592
    v_mfma_f32_16x16x32_bf16 v[104:107], v[52:55], v[168:171], v[104:107]
    v_cvt_pk_bf16_f32 v66, v68, v69
    v_cvt_pk_bf16_f32 v67, v70, v71
    v_cvt_pk_bf16_f32 v68, v72, v73
    v_cvt_pk_bf16_f32 v69, v74, v75
    v_mfma_f32_16x16x32_bf16 v[100:103], v[48:51], v[172:175], v[100:103]
    v_cvt_pk_bf16_f32 v70, v76, v77
    v_cvt_pk_bf16_f32 v71, v78, v79
    v_mfma_f32_16x16x32_bf16 v[108:111], v[52:55], v[172:175], v[108:111]
    v_permlane16_swap_b32 v64, v66
    v_permlane16_swap_b32 v65, v67
    s_waitcnt lgkmcnt(4)
    v_mfma_f32_16x16x32_bf16 v[96:99], v[32:35], v[176:179], v[96:99]
    s_waitcnt vmcnt(9)
    s_barrier
    v_add_u32 v9, 0xfffe0000, v9
    ds_read_b64_tr_b16 v[48:49], v9 offset:0
    ds_read_b64_tr_b16 v[50:51], v9 offset:256
    ds_read_b64_tr_b16 v[52:53], v9 offset:4096
    ds_read_b64_tr_b16 v[54:55], v9 offset:4352
    s_add_u32 m0, s57, 0x10000
    s_add_u32 s48, s50, 0
    v_mfma_f32_16x16x32_bf16 v[104:107], v[36:39], v[176:179], v[104:107]
    s_and_b32 s48, s48, 7
    s_mul_i32 s49, s48, 229376
    s_add_u32 s49, s49, s97
    buffer_load_dwordx4 v14, s[40:43], s49 offen offset:0 lds
    v_permlane16_swap_b32 v68, v70
    v_permlane16_swap_b32 v69, v71
    v_mfma_f32_16x16x32_bf16 v[100:103], v[32:35], v[180:183], v[100:103]
    buffer_store_dwordx4 v[64:67], v1, s[28:31], s91 offen sc1
    v_mfma_f32_16x16x32_bf16 v[108:111], v[36:39], v[180:183], v[108:111]
    s_waitcnt lgkmcnt(4)
    v_mfma_f32_16x16x32_bf16 v[96:99], v[40:43], v[184:187], v[96:99]
    ds_read_b64_tr_b16 v[32:33], v9 offset:2048
    ds_read_b64_tr_b16 v[34:35], v9 offset:2304
    ds_read_b64_tr_b16 v[36:37], v9 offset:6144
    ds_read_b64_tr_b16 v[38:39], v9 offset:6400
    v_mfma_f32_16x16x32_bf16 v[104:107], v[44:47], v[184:187], v[104:107]
    s_add_u32 m0, s57, 0x12000
    s_nop 0
    buffer_load_dwordx4 v14, s[44:47], s49 offen offset:0 lds
    buffer_store_dwordx4 v[68:71], v1, s[28:31], s94 offen sc1
    v_mfma_f32_16x16x32_bf16 v[100:103], v[40:43], v[188:191], v[100:103]
    s_mov_b32 s92, 0xbfb8aa3b
    s_mov_b32 s93, s92
    s_mov_b32 s12, 1.0
    s_mov_b32 s13, 1.0
    s_add_u32 s32, s14, 0x600000
    s_addc_u32 s33, s15, 0
    s_mov_b32 s34, 0x700000
    s_mov_b32 s35, 0x20000
    v_mfma_f32_16x16x32_bf16 v[108:111], v[44:47], v[188:191], v[108:111]
    s_waitcnt lgkmcnt(4)
    v_mfma_f32_16x16x32_bf16 v[96:99], v[48:51], v[192:195], v[96:99]
    ds_read_b64_tr_b16 v[40:41], v9 offset:8192
    ds_read_b64_tr_b16 v[42:43], v9 offset:8448
    ds_read_b64_tr_b16 v[44:45], v9 offset:12288
    ds_read_b64_tr_b16 v[46:47], v9 offset:12544
    s_add_u32 m0, s57, 0x14000
    v_mfma_f32_16x16x32_bf16 v[104:107], v[52:55], v[192:195], v[104:107]
    s_add_u32 s48, s50, 1
    s_and_b32 s48, s48, 7
    s_mul_i32 s49, s48, 229376
    s_add_u32 s49, s49, s97
    buffer_load_dwordx4 v14, s[40:43], s49 offen offset:0 lds
    v_mfma_f32_16x16x32_bf16 v[100:103], v[48:51], v[196:199], v[100:103]
    v_mfma_f32_16x16x32_bf16 v[108:111], v[52:55], v[196:199], v[108:111]
    s_waitcnt lgkmcnt(4)
    v_mfma_f32_16x16x32_bf16 v[96:99], v[32:35], v[200:203], v[96:99]
    ds_read_b64_tr_b16 v[48:49], v9 offset:10240
    ds_read_b64_tr_b16 v[50:51], v9 offset:10496
    ds_read_b64_tr_b16 v[52:53], v9 offset:14336
    ds_read_b64_tr_b16 v[54:55], v9 offset:14592
    v_mfma_f32_16x16x32_bf16 v[104:107], v[36:39], v[200:203], v[104:107]
    s_add_u32 m0, s57, 0x16000
    s_nop 0
    buffer_load_dwordx4 v14, s[44:47], s49 offen offset:0 lds
    v_mfma_f32_16x16x32_bf16 v[100:103], v[32:35], v[204:207], v[100:103]
    v_mfma_f32_16x16x32_bf16 v[108:111], v[36:39], v[204:207], v[108:111]
    s_waitcnt lgkmcnt(4)
    v_mfma_f32_16x16x32_bf16 v[96:99], v[40:43], v[208:211], v[96:99]
    s_waitcnt vmcnt(8)
    s_barrier
    v_add_u32 v9, 0x8000, v9
    ds_read_b64_tr_b16 v[32:33], v9 offset:0
    ds_read_b64_tr_b16 v[34:35], v9 offset:256
    ds_read_b64_tr_b16 v[36:37], v9 offset:4096
    ds_read_b64_tr_b16 v[38:39], v9 offset:4352
    s_add_u32 m0, s57, 0x18000
    v_mfma_f32_16x16x32_bf16 v[104:107], v[44:47], v[208:211], v[104:107]
    s_add_u32 s48, s50, 2
    s_and_b32 s48, s48, 7
    s_mul_i32 s49, s48, 229376
    s_add_u32 s49, s49, s97
    buffer_load_dwordx4 v14, s[40:43], s49 offen offset:0 lds
    v_mfma_f32_16x16x32_bf16 v[100:103], v[40:43], v[212:215], v[100:103]
    v_mfma_f32_16x16x32_bf16 v[108:111], v[44:47], v[212:215], v[108:111]
    s_waitcnt lgkmcnt(4)
    v_mfma_f32_16x16x32_bf16 v[96:99], v[48:51], v[216:219], v[96:99]
    ds_read_b64_tr_b16 v[40:41], v9 offset:2048
    ds_read_b64_tr_b16 v[42:43], v9 offset:2304
    ds_read_b64_tr_b16 v[44:45], v9 offset:6144
    ds_read_b64_tr_b16 v[46:47], v9 offset:6400
    v_mfma_f32_16x16x32_bf16 v[104:107], v[52:55], v[216:219], v[104:107]
    s_add_u32 m0, s57, 0x1a000
    s_nop 0
    buffer_load_dwordx4 v14, s[44:47], s49 offen offset:0 lds
    v_mfma_f32_16x16x32_bf16 v[100:103], v[48:51], v[220:223], v[100:103]
    v_mfma_f32_16x16x32_bf16 v[108:111], v[52:55], v[220:223], v[108:111]
    s_waitcnt lgkmcnt(4)
    v_mfma_f32_16x16x32_bf16 v[96:99], v[32:35], v[224:227], v[96:99]
    ds_read_b64_tr_b16 v[48:49], v9 offset:8192
    ds_read_b64_tr_b16 v[50:51], v9 offset:8448
    ds_read_b64_tr_b16 v[52:53], v9 offset:12288
    ds_read_b64_tr_b16 v[54:55], v9 offset:12544
    s_add_u32 m0, s57, 0x1c000
    v_mfma_f32_16x16x32_bf16 v[104:107], v[36:39], v[224:227], v[104:107]
    s_add_u32 s48, s50, 3
    s_and_b32 s48, s48, 7
    s_mul_i32 s49, s48, 229376
    s_add_u32 s49, s49, s97
    buffer_load_dwordx4 v14, s[40:43], s49 offen offset:0 lds
    v_mfma_f32_16x16x32_bf16 v[100:103], v[32:35], v[228:231], v[100:103]
    v_mfma_f32_16x16x32_bf16 v[108:111], v[36:39], v[228:231], v[108:111]
    s_waitcnt lgkmcnt(4)
    v_mfma_f32_16x16x32_bf16 v[96:99], v[40:43], v[232:235], v[96:99]
    ds_read_b64_tr_b16 v[32:33], v9 offset:10240
    ds_read_b64_tr_b16 v[34:35], v9 offset:10496
    ds_read_b64_tr_b16 v[36:37], v9 offset:14336
    ds_read_b64_tr_b16 v[38:39], v9 offset:14592
    v_mfma_f32_16x16x32_bf16 v[104:107], v[44:47], v[232:235], v[104:107]
    s_add_u32 m0, s57, 0x1e000
    s_nop 0
    buffer_load_dwordx4 v14, s[44:47], s49 offen offset:0 lds
    v_mfma_f32_16x16x32_bf16 v[100:103], v[40:43], v[236:239], v[100:103]
    v_mfma_f32_16x16x32_bf16 v[108:111], v[44:47], v[236:239], v[108:111]
    s_waitcnt lgkmcnt(4)
    v_mfma_f32_16x16x32_bf16 v[96:99], v[48:51], v[240:243], v[96:99]
    v_mfma_f32_16x16x32_bf16 v[104:107], v[52:55], v[240:243], v[104:107]
    v_mfma_f32_16x16x32_bf16 v[100:103], v[48:51], v[244:247], v[100:103]
    v_mfma_f32_16x16x32_bf16 v[108:111], v[52:55], v[244:247], v[108:111]
    s_waitcnt lgkmcnt(0)
    v_mfma_f32_16x16x32_bf16 v[96:99], v[32:35], v[248:251], v[96:99]
    s_waitcnt vmcnt(4)
    s_barrier
    s_lshl_b32 s38, s19, 4
    v_mov_b32 v20, 1
    s_mov_b64 exec, 1
    buffer_atomic_add v20, v22, s[84:87], s38 offen sc1
    s_mov_b64 exec, -1
    ds_read_b64_tr_b16 v[48:49], v7 offset:0
    ds_read_b64_tr_b16 v[50:51], v7 offset:512
    ds_read_b64_tr_b16 v[52:53], v7 offset:8192
    ds_read_b64_tr_b16 v[54:55], v7 offset:8704
    s_add_u32 m0, s57, 0x20000
    v_mfma_f32_16x16x32_bf16 v[104:107], v[36:39], v[248:251], v[104:107]
    s_add_u32 s48, s50, 4
    s_and_b32 s48, s48, 7
    s_mul_i32 s49, s48, 229376
    s_add_u32 s49, s49, s97
    buffer_load_dwordx4 v14, s[40:43], s49 offen offset:0 lds
    v_mfma_f32_16x16x32_bf16 v[100:103], v[32:35], v[252:255], v[100:103]
    ds_read_b64_tr_b16 v[56:57], v8 offset:0
    ds_read_b64_tr_b16 v[58:59], v8 offset:512
    v_mfma_f32_16x16x32_bf16 v[108:111], v[36:39], v[252:255], v[108:111]
    ds_read_b64_tr_b16 v[60:61], v8 offset:8192
    ds_read_b64_tr_b16 v[62:63], v8 offset:8704
    s_waitcnt lgkmcnt(4)
    v_mfma_f32_16x16x32_bf16 v[64:67], v[48:51], v[128:131], 0
    ds_read_b64_tr_b16 v[32:33], v7 offset:4096
    ds_read_b64_tr_b16 v[34:35], v7 offset:4608
    v_mfma_f32_16x16x32_bf16 v[72:75], v[52:55], v[128:131], 0
    ds_read_b64_tr_b16 v[36:37], v7 offset:12288
    ds_read_b64_tr_b16 v[38:39], v7 offset:12800
    s_waitcnt lgkmcnt(4)
    v_mfma_f32_16x16x32_bf16 v[80:83], v[56:59], v[128:131], 0
    s_add_u32 m0, s57, 0x22000
    s_nop 0
    v_mfma_f32_16x16x32_bf16 v[88:91], v[60:63], v[128:131], 0
    buffer_load_dwordx4 v14, s[44:47], s49 offen offset:0 lds
    v_mfma_f32_16x16x32_bf16 v[68:71], v[48:51], v[132:135], 0
    ds_read_b64_tr_b16 v[40:41], v8 offset:4096
    v_mfma_f32_16x16x32_bf16 v[76:79], v[52:55], v[132:135], 0
    ds_read_b64_tr_b16 v[42:43], v8 offset:4608
    v_mfma_f32_16x16x32_bf16 v[84:87], v[56:59], v[132:135], 0
    ds_read_b64_tr_b16 v[44:45], v8 offset:12288
    v_mfma_f32_16x16x32_bf16 v[92:95], v[60:63], v[132:135], 0
    ds_read_b64_tr_b16 v[46:47], v8 offset:12800
    s_waitcnt lgkmcnt(4)
    v_mfma_f32_16x16x32_bf16 v[64:67], v[32:35], v[136:139], v[64:67]
    ds_read_b64_tr_b16 v[48:49], v7 offset:16384
    ds_read_b64_tr_b16 v[50:51], v7 offset:16896
    ds_read_b64_tr_b16 v[52:53], v7 offset:24576
    v_mfma_f32_16x16x32_bf16 v[72:75], v[36:39], v[136:139], v[72:75]
    ds_read_b64_tr_b16 v[54:55], v7 offset:25088
    s_add_u32 m0, s57, 0x24000
    s_add_u32 s48, s50, 5
    s_waitcnt lgkmcnt(4)
    v_mfma_f32_16x16x32_bf16 v[80:83], v[40:43], v[136:139], v[80:83]
    s_and_b32 s48, s48, 7
    s_mul_i32 s49, s48, 229376
    s_add_u32 s49, s49, s97
    v_mfma_f32_16x16x32_bf16 v[88:91], v[44:47], v[136:139], v[88:91]
    buffer_load_dwordx4 v14, s[40:43], s49 offen offset:0 lds
    v_mfma_f32_16x16x32_bf16 v[68:71], v[32:35], v[140:143], v[68:71]
    ds_read_b64_tr_b16 v[56:57], v8 offset:16384
    ds_read_b64_tr_b16 v[58:59], v8 offset:16896
    ds_read_b64_tr_b16 v[60:61], v8 offset:24576
    ds_read_b64_tr_b16 v[62:63], v8 offset:25088
    v_mfma_f32_16x16x32_bf16 v[76:79], v[36:39], v[140:143], v[76:79]
    v_mul_f32 v128, s92, v96
    v_mul_f32 v129, s92, v97
    v_mul_f32 v130, s92, v98
    v_mul_f32 v131, s92, v99
    v_mfma_f32_16x16x32_bf16 v[84:87], v[40:43], v[140:143], v[84:87]
    v_mul_f32 v132, s92, v100
    v_mul_f32 v133, s92, v101
    v_mul_f32 v134, s92, v102
    v_mul_f32 v135, s92, v103
    v_mfma_f32_16x16x32_bf16 v[92:95], v[44:47], v[140:143], v[92:95]
    v_exp_f32 v128, v128
    s_waitcnt lgkmcnt(4)
    v_mfma_f32_16x16x32_bf16 v[64:67], v[48:51], v[144:147], v[64:67]
    ds_read_b64_tr_b16 v[32:33], v7 offset:20480
    ds_read_b64_tr_b16 v[34:35], v7 offset:20992
    ds_read_b64_tr_b16 v[36:37], v7 offset:28672
    ds_read_b64_tr_b16 v[38:39], v7 offset:29184
    s_add_u32 m0, s57, 0x26000
    v_mfma_f32_16x16x32_bf16 v[72:75], v[52:55], v[144:147], v[72:75]
    s_nop 0
    buffer_load_dwordx4 v14, s[44:47], s49 offen offset:0 lds
    v_exp_f32 v129, v129
    v_exp_f32 v130, v130
    v_exp_f32 v131, v131
    s_waitcnt lgkmcnt(4)
    v_mfma_f32_16x16x32_bf16 v[80:83], v[56:59], v[144:147], v[80:83]
    v_exp_f32 v132, v132
    v_exp_f32 v133, v133
    v_exp_f32 v134, v134
    v_exp_f32 v135, v135
    v_mul_f32 v96, v104, v96
    v_mfma_f32_16x16x32_bf16 v[88:91], v[60:63], v[144:147], v[88:91]
    v_mul_f32 v97, v105, v97
    s_mov_b32 s28, s76
    s_mov_b32 s29, s77
    s_mov_b32 s30, 0x1c0000
    s_mov_b32 s31, 0x20000
    s_lshl_b32 s94, s2, 3
    s_add_u32 s94, s94, s3
    s_mul_i32 s96, s94, 896
    v_lshlrev_b32 v29, 7, v0
    s_mov_b64 exec, 0x7f
    buffer_load_dword v30, v29, s[28:31], s96 offen
    s_mov_b32 s28, s78
    s_mov_b32 s29, s79
    s_mov_b32 s30, 0x80000
    s_mov_b32 s31, 0x20000
    s_lshl_b32 s96, s94, 8
    s_mov_b64 exec, 3
    buffer_load_dword v30, v29, s[28:31], s96 offen
    s_mov_b64 exec, -1
    v_mfma_f32_16x16x32_bf16 v[68:71], v[48:51], v[148:151], v[68:71]
    ds_read_b64_tr_b16 v[40:41], v8 offset:20480
    ds_read_b64_tr_b16 v[42:43], v8 offset:20992
    ds_read_b64_tr_b16 v[44:45], v8 offset:28672
    ds_read_b64_tr_b16 v[46:47], v8 offset:29184
    v_mfma_f32_16x16x32_bf16 v[76:79], v[52:55], v[148:151], v[76:79]
    v_mul_f32 v98, v106, v98
    v_mul_f32 v99, v107, v99
    v_mul_f32 v100, v108, v100
    v_mul_f32 v101, v109, v101
    v_mfma_f32_16x16x32_bf16 v[84:87], v[56:59], v[148:151], v[84:87]
    v_mul_f32 v102, v110, v102
    v_mul_f32 v103, v111, v103
    v_add_f32 v128, 1.0, v128
    v_add_f32 v129, 1.0, v129
    v_mfma_f32_16x16x32_bf16 v[92:95], v[60:63], v[148:151], v[92:95]
    v_add_f32 v130, 1.0, v130
    s_waitcnt lgkmcnt(4)
    v_mfma_f32_16x16x32_bf16 v[64:67], v[32:35], v[152:155], v[64:67]
    s_waitcnt vmcnt(7)
    s_barrier
    v_mov_b32 v20, 1
    s_mov_b64 exec, 1
    buffer_store_dword v20, v22, s[80:83], s90 offen sc1
    s_mov_b64 exec, -1
    v_add_u32 v7, 0x8000, v7
    v_add_u32 v8, 0x8000, v8
    ds_read_b64_tr_b16 v[48:49], v7 offset:0
    ds_read_b64_tr_b16 v[50:51], v7 offset:512
    ds_read_b64_tr_b16 v[52:53], v7 offset:8192
    ds_read_b64_tr_b16 v[54:55], v7 offset:8704
    v_mfma_f32_16x16x32_bf16 v[72:75], v[36:39], v[152:155], v[72:75]
    s_add_u32 m0, s57, 0x0
    s_add_u32 s48, s50, 6
    s_and_b32 s48, s48, 7
    s_mul_i32 s49, s48, 229376
    s_add_u32 s49, s49, s97
    buffer_load_dwordx4 v14, s[40:43], s49 offen offset:0 lds
    s_waitcnt lgkmcnt(4)
    v_mfma_f32_16x16x32_bf16 v[80:83], v[40:43], v[152:155], v[80:83]
    v_add_f32 v131, 1.0, v131
    v_add_f32 v132, 1.0, v132
    v_add_f32 v133, 1.0, v133
    v_add_f32 v134, 1.0, v134
    v_add_f32 v135, 1.0, v135
    v_rcp_f32 v128, v128
    v_mfma_f32_16x16x32_bf16 v[88:91], v[44:47], v[152:155], v[88:91]
    v_rcp_f32 v129, v129
    v_rcp_f32 v130, v130
    v_rcp_f32 v131, v131
    v_mfma_f32_16x16x32_bf16 v[68:71], v[32:35], v[156:159], v[68:71]
    ds_read_b64_tr_b16 v[56:57], v8 offset:0
    ds_read_b64_tr_b16 v[58:59], v8 offset:512
    ds_read_b64_tr_b16 v[60:61], v8 offset:8192
    ds_read_b64_tr_b16 v[62:63], v8 offset:8704
    v_mfma_f32_16x16x32_bf16 v[76:79], v[36:39], v[156:159], v[76:79]
    v_rcp_f32 v132, v132
    v_rcp_f32 v133, v133
    v_rcp_f32 v134, v134
    v_rcp_f32 v135, v135
    v_mfma_f32_16x16x32_bf16 v[84:87], v[40:43], v[156:159], v[84:87]
    s_nop 0
    v_mul_f32 v96, v128, v96
    v_mul_f32 v97, v129, v97
    v_mul_f32 v98, v130, v98
    v_mfma_f32_16x16x32_bf16 v[92:95], v[44:47], v[156:159], v[92:95]
    v_mul_f32 v99, v131, v99
    s_waitcnt lgkmcnt(4)
    v_mfma_f32_16x16x32_bf16 v[64:67], v[48:51], v[160:163], v[64:67]
    ds_read_b64_tr_b16 v[32:33], v7 offset:4096
    ds_read_b64_tr_b16 v[34:35], v7 offset:4608
    ds_read_b64_tr_b16 v[36:37], v7 offset:12288
    ds_read_b64_tr_b16 v[38:39], v7 offset:12800
    v_mfma_f32_16x16x32_bf16 v[72:75], v[52:55], v[160:163], v[72:75]
    s_add_u32 m0, s57, 0x2000
    s_nop 0
    buffer_load_dwordx4 v14, s[44:47], s49 offen offset:0 lds
    v_mul_f32 v100, v132, v100
    s_waitcnt lgkmcnt(4)
    v_mfma_f32_16x16x32_bf16 v[80:83], v[56:59], v[160:163], v[80:83]
    v_mul_f32 v101, v133, v101
    v_mul_f32 v102, v134, v102
    v_mul_f32 v103, v135, v103
    v_cvt_pk_bf16_f32 v96, v96, v97
    v_mfma_f32_16x16x32_bf16 v[88:91], v[60:63], v[160:163], v[88:91]
    v_cvt_pk_bf16_f32 v97, v98, v99
    v_cvt_pk_bf16_f32 v98, v100, v101
    v_cvt_pk_bf16_f32 v99, v102, v103
    s_nop 0
    v_mfma_f32_16x16x32_bf16 v[68:71], v[48:51], v[164:167], v[68:71]
    ds_read_b64_tr_b16 v[40:41], v8 offset:4096
    ds_read_b64_tr_b16 v[42:43], v8 offset:4608
    v_mfma_f32_16x16x32_bf16 v[76:79], v[52:55], v[164:167], v[76:79]
    ds_read_b64_tr_b16 v[44:45], v8 offset:12288
    ds_read_b64_tr_b16 v[46:47], v8 offset:12800
    v_mfma_f32_16x16x32_bf16 v[84:87], v[56:59], v[164:167], v[84:87]
    v_permlane16_swap_b32 v96, v98
    v_permlane16_swap_b32 v97, v99
    v_mfma_f32_16x16x32_bf16 v[92:95], v[60:63], v[164:167], v[92:95]
    buffer_store_dwordx4 v[96:99], v1, s[32:35], s95 offen offset:0 sc1
    s_waitcnt lgkmcnt(4)
    v_mfma_f32_16x16x32_bf16 v[64:67], v[32:35], v[168:171], v[64:67]
    ds_read_b64_tr_b16 v[48:49], v7 offset:16384
    ds_read_b64_tr_b16 v[50:51], v7 offset:16896
    ds_read_b64_tr_b16 v[52:53], v7 offset:24576
    ds_read_b64_tr_b16 v[54:55], v7 offset:25088
    s_add_u32 m0, s57, 0x4000
    v_mfma_f32_16x16x32_bf16 v[72:75], v[36:39], v[168:171], v[72:75]
    s_add_u32 s48, s50, 7
    s_and_b32 s48, s48, 7
    s_mul_i32 s49, s48, 229376
    s_add_u32 s49, s49, s97
    buffer_load_dwordx4 v14, s[40:43], s49 offen offset:0 lds
    s_waitcnt lgkmcnt(4)
    v_mfma_f32_16x16x32_bf16 v[80:83], v[40:43], v[168:171], v[80:83]
    v_and_b32 v3, 31, v0
    v_cmp_eq_u32 s[20:21], 16, v3
    v_mov_b32 v3, 0x3f803f80
    s_nop 0
    v_cndmask_b32 v152, 0, v3, s[20:21]
    v_mfma_f32_16x16x32_bf16 v[88:91], v[44:47], v[168:171], v[88:91]
    v_mov_b32 v153, v152
    v_mov_b32 v154, v152
    v_mov_b32 v155, v152
    v_mov_b32 v156, v152
    v_mov_b32 v157, v152
    v_mfma_f32_16x16x32_bf16 v[68:71], v[32:35], v[172:175], v[68:71]
    ds_read_b64_tr_b16 v[56:57], v8 offset:16384
    ds_read_b64_tr_b16 v[58:59], v8 offset:16896
    ds_read_b64_tr_b16 v[60:61], v8 offset:24576
    ds_read_b64_tr_b16 v[62:63], v8 offset:25088
    v_mfma_f32_16x16x32_bf16 v[76:79], v[36:39], v[172:175], v[76:79]
    v_mov_b32 v158, v152
    v_mov_b32 v159, v152
    v_mov_b32 v160, v152
    v_mov_b32 v161, v152
    v_mfma_f32_16x16x32_bf16 v[84:87], v[40:43], v[172:175], v[84:87]
    v_mov_b32 v162, v152
    v_mov_b32 v163, v152
    v_mov_b32 v164, v152
    v_mov_b32 v165, v152
    v_mfma_f32_16x16x32_bf16 v[92:95], v[44:47], v[172:175], v[92:95]
    v_mov_b32 v166, v152
    v_mov_b32 v167, v152
    s_waitcnt lgkmcnt(4)
    v_mfma_f32_16x16x32_bf16 v[64:67], v[48:51], v[176:179], v[64:67]
    ds_read_b64_tr_b16 v[32:33], v7 offset:20480
    ds_read_b64_tr_b16 v[34:35], v7 offset:20992
    v_mfma_f32_16x16x32_bf16 v[72:75], v[52:55], v[176:179], v[72:75]
    ds_read_b64_tr_b16 v[36:37], v7 offset:28672
    ds_read_b64_tr_b16 v[38:39], v7 offset:29184
    s_waitcnt lgkmcnt(4)
    v_mfma_f32_16x16x32_bf16 v[80:83], v[56:59], v[176:179], v[80:83]
    s_add_u32 m0, s57, 0x6000
    s_nop 0
    v_mfma_f32_16x16x32_bf16 v[88:91], v[60:63], v[176:179], v[88:91]
    buffer_load_dwordx4 v14, s[44:47], s49 offen offset:0 lds
    v_mfma_f32_16x16x32_bf16 v[68:71], v[48:51], v[180:183], v[68:71]
    ds_read_b64_tr_b16 v[40:41], v8 offset:20480
    v_mfma_f32_16x16x32_bf16 v[76:79], v[52:55], v[180:183], v[76:79]
    ds_read_b64_tr_b16 v[42:43], v8 offset:20992
    v_mfma_f32_16x16x32_bf16 v[84:87], v[56:59], v[180:183], v[84:87]
    ds_read_b64_tr_b16 v[44:45], v8 offset:28672
    v_mfma_f32_16x16x32_bf16 v[92:95], v[60:63], v[180:183], v[92:95]
    ds_read_b64_tr_b16 v[46:47], v8 offset:29184
    s_waitcnt lgkmcnt(4)
    v_mfma_f32_16x16x32_bf16 v[64:67], v[32:35], v[184:187], v[64:67]
    s_waitcnt vmcnt(8)
    s_barrier
    v_add_u32 v7, 0x8000, v7
    v_add_u32 v8, 0x8000, v8
    v_mfma_f32_16x16x32_bf16 v[72:75], v[36:39], v[184:187], v[72:75]
    ds_read_b64_tr_b16 v[48:49], v7 offset:0
    ds_read_b64_tr_b16 v[50:51], v7 offset:512
    s_waitcnt lgkmcnt(2)
    v_mfma_f32_16x16x32_bf16 v[80:83], v[40:43], v[184:187], v[80:83]
    ds_read_b64_tr_b16 v[52:53], v7 offset:8192
    ds_read_b64_tr_b16 v[54:55], v7 offset:8704
    v_mfma_f32_16x16x32_bf16 v[88:91], v[44:47], v[184:187], v[88:91]
    v_mfma_f32_16x16x32_bf16 v[68:71], v[32:35], v[188:191], v[68:71]
    ds_read_b64_tr_b16 v[56:57], v8 offset:0
    v_mfma_f32_16x16x32_bf16 v[76:79], v[36:39], v[188:191], v[76:79]
    ds_read_b64_tr_b16 v[58:59], v8 offset:512
    v_mfma_f32_16x16x32_bf16 v[84:87], v[40:43], v[188:191], v[84:87]
    ds_read_b64_tr_b16 v[60:61], v8 offset:8192
    v_mfma_f32_16x16x32_bf16 v[92:95], v[44:47], v[188:191], v[92:95]
    ds_read_b64_tr_b16 v[62:63], v8 offset:8704
    s_waitcnt lgkmcnt(4)
    v_mfma_f32_16x16x32_bf16 v[64:67], v[48:51], v[192:195], v[64:67]
    ds_read_b64_tr_b16 v[32:33], v7 offset:4096
    v_mfma_f32_16x16x32_bf16 v[72:75], v[52:55], v[192:195], v[72:75]
    ds_read_b64_tr_b16 v[34:35], v7 offset:4608
    s_waitcnt lgkmcnt(2)
    v_mfma_f32_16x16x32_bf16 v[80:83], v[56:59], v[192:195], v[80:83]
    ds_read_b64_tr_b16 v[36:37], v7 offset:12288
    v_mfma_f32_16x16x32_bf16 v[88:91], v[60:63], v[192:195], v[88:91]
    ds_read_b64_tr_b16 v[38:39], v7 offset:12800
    v_mfma_f32_16x16x32_bf16 v[68:71], v[48:51], v[196:199], v[68:71]
    ds_read_b64_tr_b16 v[40:41], v8 offset:4096
    v_mfma_f32_16x16x32_bf16 v[76:79], v[52:55], v[196:199], v[76:79]
    ds_read_b64_tr_b16 v[42:43], v8 offset:4608
    v_mfma_f32_16x16x32_bf16 v[84:87], v[56:59], v[196:199], v[84:87]
    ds_read_b64_tr_b16 v[44:45], v8 offset:12288
    v_mfma_f32_16x16x32_bf16 v[92:95], v[60:63], v[196:199], v[92:95]
    ds_read_b64_tr_b16 v[46:47], v8 offset:12800
    s_waitcnt lgkmcnt(4)
    v_mfma_f32_16x16x32_bf16 v[64:67], v[32:35], v[200:203], v[64:67]
    ds_read_b64_tr_b16 v[48:49], v7 offset:16384
    v_mfma_f32_16x16x32_bf16 v[72:75], v[36:39], v[200:203], v[72:75]
    ds_read_b64_tr_b16 v[50:51], v7 offset:16896
    s_waitcnt lgkmcnt(2)
    v_mfma_f32_16x16x32_bf16 v[80:83], v[40:43], v[200:203], v[80:83]
    ds_read_b64_tr_b16 v[52:53], v7 offset:24576
    v_mfma_f32_16x16x32_bf16 v[88:91], v[44:47], v[200:203], v[88:91]
    ds_read_b64_tr_b16 v[54:55], v7 offset:25088
    v_mfma_f32_16x16x32_bf16 v[68:71], v[32:35], v[204:207], v[68:71]
    ds_read_b64_tr_b16 v[56:57], v8 offset:16384
    ds_read_b64_tr_b16 v[58:59], v8 offset:16896
    v_mfma_f32_16x16x32_bf16 v[76:79], v[36:39], v[204:207], v[76:79]
    ds_read_b64_tr_b16 v[60:61], v8 offset:24576
    ds_read_b64_tr_b16 v[62:63], v8 offset:25088
    v_mfma_f32_16x16x32_bf16 v[84:87], v[40:43], v[204:207], v[84:87]
    buffer_load_dword v20, v21, s[84:87], 0 offen sc1
    v_mfma_f32_16x16x32_bf16 v[92:95], v[44:47], v[204:207], v[92:95]
    s_waitcnt lgkmcnt(4)
    v_mfma_f32_16x16x32_bf16 v[64:67], v[48:51], v[208:211], v[64:67]
    ds_read_b64_tr_b16 v[32:33], v7 offset:20480
    v_mfma_f32_16x16x32_bf16 v[72:75], v[52:55], v[208:211], v[72:75]
    ds_read_b64_tr_b16 v[34:35], v7 offset:20992
    s_waitcnt lgkmcnt(2)
    v_mfma_f32_16x16x32_bf16 v[80:83], v[56:59], v[208:211], v[80:83]
    ds_read_b64_tr_b16 v[36:37], v7 offset:28672
    v_mfma_f32_16x16x32_bf16 v[88:91], v[60:63], v[208:211], v[88:91]
    ds_read_b64_tr_b16 v[38:39], v7 offset:29184
    v_mfma_f32_16x16x32_bf16 v[68:71], v[48:51], v[212:215], v[68:71]
    ds_read_b64_tr_b16 v[40:41], v8 offset:20480
    v_mfma_f32_16x16x32_bf16 v[76:79], v[52:55], v[212:215], v[76:79]
    ds_read_b64_tr_b16 v[42:43], v8 offset:20992
    v_mfma_f32_16x16x32_bf16 v[84:87], v[56:59], v[212:215], v[84:87]
    ds_read_b64_tr_b16 v[44:45], v8 offset:28672
    v_mfma_f32_16x16x32_bf16 v[92:95], v[60:63], v[212:215], v[92:95]
    ds_read_b64_tr_b16 v[46:47], v8 offset:29184
    s_waitcnt lgkmcnt(4)
    v_mfma_f32_16x16x32_bf16 v[64:67], v[32:35], v[216:219], v[64:67]
    s_waitcnt vmcnt(1)
    s_waitcnt lgkmcnt(0)
    s_barrier
    v_add_u32 v7, 0xfffe0000, v7
    v_add_u32 v8, 0xfffe0000, v8
    v_mfma_f32_16x16x32_bf16 v[72:75], v[36:39], v[216:219], v[72:75]
    ds_read_b64_tr_b16 v[48:49], v7 offset:0
    ds_read_b64_tr_b16 v[50:51], v7 offset:512
    v_mfma_f32_16x16x32_bf16 v[80:83], v[40:43], v[216:219], v[80:83]
    ds_read_b64_tr_b16 v[52:53], v7 offset:8192
    ds_read_b64_tr_b16 v[54:55], v7 offset:8704
    v_mfma_f32_16x16x32_bf16 v[88:91], v[44:47], v[216:219], v[88:91]
    v_mfma_f32_16x16x32_bf16 v[68:71], v[32:35], v[220:223], v[68:71]
    ds_read_b64_tr_b16 v[56:57], v8 offset:0
    v_mfma_f32_16x16x32_bf16 v[76:79], v[36:39], v[220:223], v[76:79]
    ds_read_b64_tr_b16 v[58:59], v8 offset:512
    v_mfma_f32_16x16x32_bf16 v[84:87], v[40:43], v[220:223], v[84:87]
    ds_read_b64_tr_b16 v[60:61], v8 offset:8192
    v_mfma_f32_16x16x32_bf16 v[92:95], v[44:47], v[220:223], v[92:95]
    ds_read_b64_tr_b16 v[62:63], v8 offset:8704
    s_waitcnt lgkmcnt(4)
    v_mfma_f32_16x16x32_bf16 v[64:67], v[48:51], v[224:227], v[64:67]
    ds_read_b64_tr_b16 v[32:33], v7 offset:4096
    ds_read_b64_tr_b16 v[34:35], v7 offset:4608
    v_mfma_f32_16x16x32_bf16 v[72:75], v[52:55], v[224:227], v[72:75]
    ds_read_b64_tr_b16 v[36:37], v7 offset:12288
    ds_read_b64_tr_b16 v[38:39], v7 offset:12800
    s_waitcnt lgkmcnt(4)
    v_mfma_f32_16x16x32_bf16 v[80:83], v[56:59], v[224:227], v[80:83]
    s_waitcnt vmcnt(0)
    v_cmp_le_u32 vcc, 16, v20
    s_mov_b32 s38, 0x8000
    s_cmp_eq_u64 vcc, -1
    s_cbranch_scc1 KF_SB_R_OK
KF_SB_R:
    s_sleep 12
    buffer_load_dword v20, v21, s[84:87], 0 offen sc1
    s_sub_u32 s38, s38, 1
    s_waitcnt vmcnt(0)
    v_cmp_le_u32 vcc, 16, v20
    s_cselect_b32 s39, 1, 0
    s_cmp_eq_u64 vcc, -1
    s_cselect_b32 s39, 1, s39
    s_cmp_eq_u32 s39, 0
    s_cbranch_scc1 KF_SB_R
KF_SB_R_OK:
    v_mov_b32 v21, v28
    buffer_load_dword v20, v21, s[80:83], 0 offen sc1
    v_mfma_f32_16x16x32_bf16 v[88:91], v[60:63], v[224:227], v[88:91]
    v_mfma_f32_16x16x32_bf16 v[68:71], v[48:51], v[228:231], v[68:71]
    ds_read_b64_tr_b16 v[40:41], v8 offset:4096
    v_mfma_f32_16x16x32_bf16 v[76:79], v[52:55], v[228:231], v[76:79]
    ds_read_b64_tr_b16 v[42:43], v8 offset:4608
    v_mfma_f32_16x16x32_bf16 v[84:87], v[56:59], v[228:231], v[84:87]
    ds_read_b64_tr_b16 v[44:45], v8 offset:12288
    v_mfma_f32_16x16x32_bf16 v[92:95], v[60:63], v[228:231], v[92:95]
    ds_read_b64_tr_b16 v[46:47], v8 offset:12800
    s_waitcnt lgkmcnt(4)
    v_mfma_f32_16x16x32_bf16 v[64:67], v[32:35], v[232:235], v[64:67]
    ds_read_b64_tr_b16 v[48:49], v7 offset:16384
    v_mfma_f32_16x16x32_bf16 v[72:75], v[36:39], v[232:235], v[72:75]
    ds_read_b64_tr_b16 v[50:51], v7 offset:16896
    s_waitcnt lgkmcnt(2)
    v_mfma_f32_16x16x32_bf16 v[80:83], v[40:43], v[232:235], v[80:83]
    ds_read_b64_tr_b16 v[52:53], v7 offset:24576
    v_mfma_f32_16x16x32_bf16 v[88:91], v[44:47], v[232:235], v[88:91]
    ds_read_b64_tr_b16 v[54:55], v7 offset:25088
    v_mfma_f32_16x16x32_bf16 v[68:71], v[32:35], v[236:239], v[68:71]
    ds_read_b64_tr_b16 v[56:57], v8 offset:16384
    v_mfma_f32_16x16x32_bf16 v[76:79], v[36:39], v[236:239], v[76:79]
    ds_read_b64_tr_b16 v[58:59], v8 offset:16896
    v_mfma_f32_16x16x32_bf16 v[84:87], v[40:43], v[236:239], v[84:87]
    ds_read_b64_tr_b16 v[60:61], v8 offset:24576
    v_mfma_f32_16x16x32_bf16 v[92:95], v[44:47], v[236:239], v[92:95]
    ds_read_b64_tr_b16 v[62:63], v8 offset:25088
    s_waitcnt lgkmcnt(4)
    v_mfma_f32_16x16x32_bf16 v[64:67], v[48:51], v[240:243], v[64:67]
    ds_read_b64_tr_b16 v[32:33], v7 offset:20480
    v_mfma_f32_16x16x32_bf16 v[72:75], v[52:55], v[240:243], v[72:75]
    ds_read_b64_tr_b16 v[34:35], v7 offset:20992
    s_waitcnt lgkmcnt(2)
    v_mfma_f32_16x16x32_bf16 v[80:83], v[56:59], v[240:243], v[80:83]
    ds_read_b64_tr_b16 v[36:37], v7 offset:28672
    v_mfma_f32_16x16x32_bf16 v[88:91], v[60:63], v[240:243], v[88:91]
    ds_read_b64_tr_b16 v[38:39], v7 offset:29184
    v_mfma_f32_16x16x32_bf16 v[68:71], v[48:51], v[244:247], v[68:71]
    ds_read_b64_tr_b16 v[40:41], v8 offset:20480
    ds_read_b64_tr_b16 v[42:43], v8 offset:20992
    v_mfma_f32_16x16x32_bf16 v[76:79], v[52:55], v[244:247], v[76:79]
    ds_read_b64_tr_b16 v[44:45], v8 offset:28672
    ds_read_b64_tr_b16 v[46:47], v8 offset:29184
    v_mfma_f32_16x16x32_bf16 v[84:87], v[56:59], v[244:247], v[84:87]
    s_waitcnt vmcnt(0)
    v_cmp_le_u32 vcc, 1, v20
    s_mov_b32 s38, 0x8000
    s_cmp_eq_u64 vcc, -1
    s_cbranch_scc1 KF_SQ_R_OK
KF_SQ_R:
    s_sleep 4
    buffer_load_dword v20, v21, s[80:83], 0 offen sc1
    s_sub_u32 s38, s38, 1
    s_waitcnt vmcnt(0)
    v_cmp_le_u32 vcc, 1, v20
    s_cselect_b32 s39, 1, 0
    s_cmp_eq_u64 vcc, -1
    s_cselect_b32 s39, 1, s39
    s_cmp_eq_u32 s39, 0
    s_cbranch_scc1 KF_SQ_R
KF_SQ_R_OK:
    buffer_load_dwordx4 v[128:131], v1, s[68:71], s36 offen sc1
    buffer_load_dwordx4 v[144:147], v1, s[8:11], s72 offen sc1
    buffer_load_dwordx4 v[132:135], v1, s[68:71], s37 offen sc1
    v_mfma_f32_16x16x32_bf16 v[92:95], v[60:63], v[244:247], v[92:95]
    s_waitcnt lgkmcnt(4)
    v_mfma_f32_16x16x32_bf16 v[64:67], v[32:35], v[248:251], v[64:67]
    v_mfma_f32_16x16x32_bf16 v[72:75], v[36:39], v[248:251], v[72:75]
    s_waitcnt lgkmcnt(0)
    v_mfma_f32_16x16x32_bf16 v[80:83], v[40:43], v[248:251], v[80:83]
    v_mfma_f32_16x16x32_bf16 v[88:91], v[44:47], v[248:251], v[88:91]
    v_mfma_f32_16x16x32_bf16 v[68:71], v[32:35], v[252:255], v[68:71]
    v_mfma_f32_16x16x32_bf16 v[76:79], v[36:39], v[252:255], v[76:79]
    v_mfma_f32_16x16x32_bf16 v[84:87], v[40:43], v[252:255], v[84:87]
    v_mfma_f32_16x16x32_bf16 v[92:95], v[44:47], v[252:255], v[92:95]
    s_setprio 3
    buffer_load_dwordx4 v[136:139], v1, s[68:71], s54 offen sc1
    buffer_load_dwordx4 v[140:143], v1, s[68:71], s55 offen sc1
    s_mov_b64 exec, s[74:75]
    buffer_load_dwordx4 v[152:155], v18, s[64:67], s72 offen sc1
    buffer_load_dwordx4 v[156:159], v18, s[64:67], s72 offen offset:512 sc1
    s_mov_b64 exec, -1
    s_add_u32 s72, s72, 1024
    s_and_b32 s72, s72, 0x3fff
    s_nop 10
    v_pk_mul_f32 v[32:33], v[64:65], s[92:93]
    v_pk_mul_f32 v[34:35], v[66:67], s[92:93]
    v_pk_mul_f32 v[36:37], v[68:69], s[92:93]
    v_pk_mul_f32 v[38:39], v[70:71], s[92:93]
    v_exp_f32 v32, v32
    v_exp_f32 v33, v33
    v_exp_f32 v34, v34
    v_exp_f32 v35, v35
    v_exp_f32 v36, v36
    v_exp_f32 v37, v37
    v_exp_f32 v38, v38
    v_exp_f32 v39, v39
    v_pk_mul_f32 v[40:41], v[80:81], s[92:93]
    v_pk_mul_f32 v[42:43], v[82:83], s[92:93]
    v_pk_mul_f32 v[44:45], v[84:85], s[92:93]
    v_pk_mul_f32 v[46:47], v[86:87], s[92:93]
    v_exp_f32 v40, v40
    v_exp_f32 v41, v41
    v_exp_f32 v42, v42
    v_exp_f32 v43, v43
    v_exp_f32 v44, v44
    v_exp_f32 v45, v45
    v_exp_f32 v46, v46
    v_exp_f32 v47, v47
    v_pk_mul_f32 v[64:65], v[64:65], v[72:73]
    v_pk_mul_f32 v[66:67], v[66:67], v[74:75]
    v_pk_mul_f32 v[68:69], v[68:69], v[76:77]
    v_pk_mul_f32 v[70:71], v[70:71], v[78:79]
    v_pk_add_f32 v[32:33], v[32:33], s[12:13]
    v_pk_add_f32 v[34:35], v[34:35], s[12:13]
    v_pk_add_f32 v[36:37], v[36:37], s[12:13]
    v_pk_add_f32 v[38:39], v[38:39], s[12:13]
    v_rcp_f32 v32, v32
    v_rcp_f32 v33, v33
    v_rcp_f32 v34, v34
    v_rcp_f32 v35, v35
    v_rcp_f32 v36, v36
    v_rcp_f32 v37, v37
    v_rcp_f32 v38, v38
    v_rcp_f32 v39, v39
    buffer_load_dwordx4 v[148:151], v1, s[8:11], s72 offen sc1
    s_mov_b64 exec, s[74:75]
    buffer_load_dwordx4 v[160:163], v18, s[64:67], s72 offen sc1
    buffer_load_dwordx4 v[164:167], v18, s[64:67], s72 offen offset:512 sc1
    s_mov_b64 exec, -1
    s_add_u32 s72, s72, 1024
    s_and_b32 s72, s72, 0x3fff
    v_pk_mul_f32 v[80:81], v[80:81], v[88:89]
    v_pk_mul_f32 v[82:83], v[82:83], v[90:91]
    v_pk_mul_f32 v[84:85], v[84:85], v[92:93]
    v_pk_mul_f32 v[86:87], v[86:87], v[94:95]
    v_pk_add_f32 v[40:41], v[40:41], s[12:13]
    v_pk_add_f32 v[42:43], v[42:43], s[12:13]
    v_pk_add_f32 v[44:45], v[44:45], s[12:13]
    v_pk_add_f32 v[46:47], v[46:47], s[12:13]
    v_rcp_f32 v40, v40
    v_rcp_f32 v41, v41
    v_rcp_f32 v42, v42
    v_rcp_f32 v43, v43
    v_rcp_f32 v44, v44
    v_rcp_f32 v45, v45
    v_rcp_f32 v46, v46
    v_rcp_f32 v47, v47
    v_pk_mul_f32 v[64:65], v[64:65], v[32:33]
    v_pk_mul_f32 v[66:67], v[66:67], v[34:35]
    v_pk_mul_f32 v[68:69], v[68:69], v[36:37]
    v_pk_mul_f32 v[70:71], v[70:71], v[38:39]
    v_cvt_pk_bf16_f32 v64, v64, v65
    v_cvt_pk_bf16_f32 v65, v66, v67
    v_cvt_pk_bf16_f32 v66, v68, v69
    v_cvt_pk_bf16_f32 v67, v70, v71
    s_nop 0
    v_permlane16_swap_b32 v64, v66
    v_permlane16_swap_b32 v65, v67
    buffer_store_dwordx4 v[64:67], v1, s[32:35], s58 offen offset:0 sc1
    v_pk_mul_f32 v[80:81], v[80:81], v[40:41]
    v_pk_mul_f32 v[82:83], v[82:83], v[42:43]
    v_pk_mul_f32 v[84:85], v[84:85], v[44:45]
    v_pk_mul_f32 v[86:87], v[86:87], v[46:47]
    v_cvt_pk_bf16_f32 v80, v80, v81
    v_cvt_pk_bf16_f32 v81, v82, v83
    v_cvt_pk_bf16_f32 v82, v84, v85
    v_cvt_pk_bf16_f32 v83, v86, v87
    s_nop 0
    v_permlane16_swap_b32 v80, v82
    v_permlane16_swap_b32 v81, v83
    buffer_store_dwordx4 v[80:83], v1, s[32:35], s58 offen offset:1024 sc1
    s_branch KF_C
AB_P:
    s_mov_b32 s28, s12
    s_mov_b32 s29, s13
    s_mov_b32 s30, 0x400
    s_mov_b32 s31, 0x20000
    s_lshl_b32 s60, s19, 3
    s_add_u32 s60, s60, s3
    s_lshl_b32 s39, s60, 10
    buffer_load_dwordx4 v[240:243], v1, s[28:31], 0 offen
    buffer_load_dwordx4 v[244:247], v1, s[20:23], s39 offen
    s_add_u32 m0, s56, 0x0
    s_add_u32 s48, s50, 0
    s_and_b32 s48, s48, 7
    s_mul_i32 s49, s48, 196608
    s_lshl_b32 s48, s48, 7
    buffer_load_dwordx4 v11, s[20:23], s48 offen offset:0 lds
    buffer_load_dwordx4 v12, s[20:23], s48 offen offset:1024 lds
    s_add_u32 m0, s57, 0x4000
    s_nop 0
    buffer_load_dwordx4 v13, s[24:27], s49 offen offset:0 lds
    s_barrier
    s_add_u32 m0, s56, 0x8000
    s_add_u32 s48, s50, 1
    s_and_b32 s48, s48, 7
    s_mul_i32 s49, s48, 196608
    s_lshl_b32 s48, s48, 7
    buffer_load_dwordx4 v11, s[20:23], s48 offen offset:0 lds
    buffer_load_dwordx4 v12, s[20:23], s48 offen offset:1024 lds
    s_add_u32 m0, s57, 0xc000
    s_nop 0
    buffer_load_dwordx4 v13, s[24:27], s49 offen offset:0 lds
    s_lshl_b32 s58, s55, 3
    s_lshr_b32 s38, 0x140e0800, s58
    s_and_b32 s38, s38, 0xff
    s_lshr_b32 s52, 0x00008000, s58
    s_and_b32 s52, s52, 0xff
    s_lshr_b32 s97, 0x80400080, s58
    s_and_b32 s97, s97, 0xff
    s_mul_i32 s58, s54, 28
    s_add_u32 s58, s58, s38
    s_lshl_b32 s38, s58, 5
    s_sub_u32 s39, 1835008, s38
    s_add_u32 s40, s8, s38
    s_addc_u32 s41, s9, 0
    s_mov_b32 s42, s39
    s_mov_b32 s43, 0x20000
    s_add_u32 s44, s10, s38
    s_addc_u32 s45, s11, 0
    s_mov_b32 s46, s39
    s_mov_b32 s47, 0x20000
    v_mul_u32_u24 v24, 3584, v23
    v_add_u32 v14, v24, v22
    s_and_b32 s38, s18, 7
    s_lshl_b32 s38, s38, 3
    s_add_u32 s38, s38, s3
    s_mul_i32 s38, s38, 28672
    s_add_u32 s38, s38, s52
    v_mul_u32_u24 v15, 3584, v0
    s_mov_b64 exec, 0xff
    buffer_load_dword v4, v15, s[40:43], s38 offen
    buffer_load_dword v4, v15, s[44:47], s38 offen
    s_mov_b64 exec, -1
    v_and_b32 v24, 15, v0
    v_lshrrev_b32 v25, 4, v0
    v_bfe_u32 v26, v0, 1, 3
    v_xor_b32 v26, v25, v26
    v_lshlrev_b32 v26, 4, v26
    v_lshl_add_u32 v26, v24, 7, v26
    s_lshl_b32 s38, s36, 12
    v_add_u32 v2, s38, v26
    v_bfe_u32 v21, v0, 2, 2
    v_lshl_add_u32 v26, v25, 3, v21
    v_bfe_u32 v27, v0, 4, 1
    v_and_b32 v28, 3, v0
    v_lshlrev_b32 v28, 3, v28
    v_bfe_u32 v30, v0, 3, 1
    v_xor_b32 v23, s37, v30
    v_lshl_add_u32 v23, v23, 1, v27
    v_lshl_add_u32 v29, v23, 5, v28
    v_lshl_add_u32 v29, v26, 7, v29
    v_add_u32 v5, 16384, v29
    v_xor_b32 v6, 32, v5
    v_add_u32 v7, 98304, v29
    v_xor_b32 v8, 32, v7
    v_lshrrev_b32 v25, 5, v0
    s_lshl_b32 s90, s18, 2
    s_add_u32 s90, s90, s36
    s_lshl_b32 s91, s90, 10
    s_mul_i32 s90, s90, 112
    s_add_u32 s90, s90, s58
    s_lshr_b32 s38, s52, 5
    s_add_u32 s95, s90, s38
    s_lshr_b32 s38, s97, 5
    s_add_u32 s58, s90, s38
    s_lshl_b32 s38, s37, 1
    s_add_u32 s58, s58, s38
    s_lshl_b32 s58, s58, 10
    s_add_u32 s95, s95, s38
    s_lshl_b32 s95, s95, 10
    s_cmp_lt_u32 s19, 8
    s_cselect_b32 s92, 0x3eb8aa3b, 1.0
    s_mov_b32 s93, s92
    s_lshl_b32 s38, s19, 18
    s_add_u32 s91, s91, s38
    s_lshl_b32 s38, s37, 17
    s_add_u32 s91, s91, s38
    s_add_u32 s94, s91, 0x10000
    s_waitcnt vmcnt(8)
    v_lshlrev_b32 v250, 16, v240
    v_and_b32 v251, 0xffff0000, v240
    v_lshlrev_b32 v252, 16, v244
    v_and_b32 v253, 0xffff0000, v244
    v_mul_f32 v250, v250, v252
    v_mul_f32 v251, v251, v253
    v_cvt_pk_bf16_f32 v250, v250, v251
    v_and_b32 v251, 0xffff0000, v250
    v_lshlrev_b32 v250, 16, v250
    v_add_f32 v248, v250, v251
    v_lshlrev_b32 v250, 16, v241
    v_and_b32 v251, 0xffff0000, v241
    v_lshlrev_b32 v252, 16, v245
    v_and_b32 v253, 0xffff0000, v245
    v_mul_f32 v250, v250, v252
    v_mul_f32 v251, v251, v253
    v_cvt_pk_bf16_f32 v250, v250, v251
    v_and_b32 v251, 0xffff0000, v250
    v_lshlrev_b32 v250, 16, v250
    v_add_f32 v250, v250, v251
    v_add_f32 v248, v248, v250
    v_lshlrev_b32 v250, 16, v242
    v_and_b32 v251, 0xffff0000, v242
    v_lshlrev_b32 v252, 16, v246
    v_and_b32 v253, 0xffff0000, v246
    v_mul_f32 v250, v250, v252
    v_mul_f32 v251, v251, v253
    v_cvt_pk_bf16_f32 v250, v250, v251
    v_and_b32 v251, 0xffff0000, v250
    v_lshlrev_b32 v250, 16, v250
    v_add_f32 v250, v250, v251
    v_add_f32 v248, v248, v250
    v_lshlrev_b32 v250, 16, v243
    v_and_b32 v251, 0xffff0000, v243
    v_lshlrev_b32 v252, 16, v247
    v_and_b32 v253, 0xffff0000, v247
    v_mul_f32 v250, v250, v252
    v_mul_f32 v251, v251, v253
    v_cvt_pk_bf16_f32 v250, v250, v251
    v_and_b32 v251, 0xffff0000, v250
    v_lshlrev_b32 v250, 16, v250
    v_add_f32 v250, v250, v251
    v_add_f32 v248, v248, v250
    s_nop 1
    v_add_f32_dpp v248, v248, v248 row_shr:1 row_mask:0xf bank_mask:0xf bound_ctrl:0
    s_nop 1
    v_add_f32_dpp v248, v248, v248 row_shr:2 row_mask:0xf bank_mask:0xf bound_ctrl:0
    s_nop 1
    v_add_f32_dpp v248, v248, v248 row_shr:4 row_mask:0xf bank_mask:0xf bound_ctrl:0
    s_nop 1
    v_add_f32_dpp v248, v248, v248 row_shr:8 row_mask:0xf bank_mask:0xf bound_ctrl:0
    s_nop 1
    v_add_f32_dpp v248, v248, v248 row_bcast:15 row_mask:0xa bank_mask:0xf
    s_nop 1
    v_add_f32_dpp v248, v248, v248 row_bcast:31 row_mask:0xc bank_mask:0xf
    v_cvt_pk_bf16_f32 v248, v248, v248
    v_and_b32 v248, 0xffff0000, v248
    v_mul_f32 v248, 0xbfb8aa3b, v248
    v_exp_f32 v248, v248
    s_nop 0
    v_add_f32 v248, 1.0, v248
    v_rcp_f32 v248, v248
    s_nop 0
    v_cvt_pk_bf16_f32 v248, v248, v248
    v_and_b32 v252, 0xffff0000, v248
    v_sub_f32 v248, 1.0, v252
    v_cvt_pk_bf16_f32 v248, v248, v248
    v_and_b32 v253, 0xffff0000, v248
    v_mov_b32 v30, v252
    v_mov_b32 v31, v253
    s_mov_b32 s28, s14
    s_mov_b32 s29, s15
    s_mov_b32 s30, 0x1100000
    s_mov_b32 s31, 0x20000
    s_lshl_b32 s39, s18, 7
    s_add_u32 s60, s60, s39
    s_lshl_b32 s60, s60, 3
    s_add_u32 s60, s60, 0x1000000
    v_mov_b32 v29, 0
    s_waitcnt vmcnt(5)
    s_barrier
    s_waitcnt lgkmcnt(0)
    ds_read_b128 v[128:131], v2 offset:0
    ds_read_b64_tr_b16 v[32:33], v5 offset:0
    ds_read_b64_tr_b16 v[34:35], v5 offset:512
    ds_read_b64_tr_b16 v[36:37], v6 offset:0
    ds_read_b64_tr_b16 v[38:39], v6 offset:512
    ds_read_b128 v[132:135], v2 offset:2048
    s_waitcnt lgkmcnt(1)
    v_mfma_f32_16x16x32_bf16 v[112:115], v[32:35], v[128:131], 0
    v_xor_b32 v3, 64, v2
    ds_read_b128 v[136:139], v3 offset:0
    ds_read_b64_tr_b16 v[40:41], v5 offset:4096
    ds_read_b64_tr_b16 v[42:43], v5 offset:4608
    ds_read_b64_tr_b16 v[44:45], v6 offset:4096
    ds_read_b64_tr_b16 v[46:47], v6 offset:4608
    s_add_u32 m0, s56, 0x10000
    v_mfma_f32_16x16x32_bf16 v[120:123], v[36:39], v[128:131], 0
    s_add_u32 s48, s50, 2
    s_and_b32 s48, s48, 7
    s_mul_i32 s49, s48, 196608
    s_lshl_b32 s48, s48, 7
    buffer_load_dwordx4 v11, s[20:23], s48 offen offset:0 lds
    buffer_load_dwordx4 v12, s[20:23], s48 offen offset:1024 lds
    s_waitcnt lgkmcnt(5)
    v_mfma_f32_16x16x32_bf16 v[116:119], v[32:35], v[132:135], 0
    ds_read_b128 v[140:143], v3 offset:2048
    s_add_u32 m0, s57, 0x14000
    s_nop 0
    buffer_load_dwordx4 v13, s[24:27], s49 offen offset:0 lds
    s_add_u32 m0, s56, 0x18000
    v_mfma_f32_16x16x32_bf16 v[124:127], v[36:39], v[132:135], 0
    s_add_u32 s48, s50, 3
    s_and_b32 s48, s48, 7
    s_mul_i32 s49, s48, 196608
    s_lshl_b32 s48, s48, 7
    buffer_load_dwordx4 v11, s[20:23], s48 offen offset:0 lds
    s_waitcnt lgkmcnt(1)
    v_mfma_f32_16x16x32_bf16 v[112:115], v[40:43], v[136:139], v[112:115]
    s_waitcnt vmcnt(6)
    s_barrier
    v_add_u32 v2, 0x8000, v2
    v_add_u32 v5, 0x8000, v5
    v_add_u32 v6, 0x8000, v6
    ds_read_b128 v[144:147], v2 offset:0
    ds_read_b64_tr_b16 v[48:49], v5 offset:0
    ds_read_b64_tr_b16 v[50:51], v5 offset:512
    v_mfma_f32_16x16x32_bf16 v[120:123], v[44:47], v[136:139], v[120:123]
    ds_read_b64_tr_b16 v[52:53], v6 offset:0
    ds_read_b64_tr_b16 v[54:55], v6 offset:512
    buffer_load_dwordx4 v12, s[20:23], s48 offen offset:1024 lds
    s_add_u32 m0, s57, 0x1c000
    s_nop 0
    buffer_load_dwordx4 v13, s[24:27], s49 offen offset:0 lds
    s_waitcnt lgkmcnt(5)
    v_mfma_f32_16x16x32_bf16 v[116:119], v[40:43], v[140:143], v[116:119]
    ds_read_b128 v[148:151], v2 offset:2048
    s_add_u32 m0, s56, 0x20000
    s_add_u32 s48, s50, 4
    s_and_b32 s48, s48, 7
    v_mfma_f32_16x16x32_bf16 v[124:127], v[44:47], v[140:143], v[124:127]
    s_mul_i32 s49, s48, 196608
    s_lshl_b32 s48, s48, 7
    buffer_load_dwordx4 v11, s[20:23], s48 offen offset:0 lds
    s_waitcnt lgkmcnt(1)
    v_mfma_f32_16x16x32_bf16 v[112:115], v[48:51], v[144:147], v[112:115]
    v_xor_b32 v3, 64, v2
    ds_read_b128 v[152:155], v3 offset:0
    ds_read_b64_tr_b16 v[56:57], v5 offset:4096
    ds_read_b64_tr_b16 v[58:59], v5 offset:4608
    v_mfma_f32_16x16x32_bf16 v[120:123], v[52:55], v[144:147], v[120:123]
    ds_read_b64_tr_b16 v[60:61], v6 offset:4096
    ds_read_b64_tr_b16 v[62:63], v6 offset:4608
    buffer_load_dwordx4 v12, s[20:23], s48 offen offset:1024 lds
    s_waitcnt lgkmcnt(5)
    v_mfma_f32_16x16x32_bf16 v[116:119], v[48:51], v[148:151], v[116:119]
    ds_read_b128 v[156:159], v3 offset:2048
    s_add_u32 m0, s57, 0x24000
    v_mfma_f32_16x16x32_bf16 v[124:127], v[52:55], v[148:151], v[124:127]
    s_nop 0
    buffer_load_dwordx4 v13, s[24:27], s49 offen offset:0 lds
    s_waitcnt lgkmcnt(1)
    v_mfma_f32_16x16x32_bf16 v[112:115], v[56:59], v[152:155], v[112:115]
    s_waitcnt vmcnt(6)
    s_barrier
    v_add_u32 v2, 0x8000, v2
    v_add_u32 v5, 0x8000, v5
    v_add_u32 v6, 0x8000, v6
    ds_read_b128 v[160:163], v2 offset:0
    ds_read_b64_tr_b16 v[32:33], v5 offset:0
    ds_read_b64_tr_b16 v[34:35], v5 offset:512
    ds_read_b64_tr_b16 v[36:37], v6 offset:0
    v_mfma_f32_16x16x32_bf16 v[120:123], v[60:63], v[152:155], v[120:123]
    ds_read_b64_tr_b16 v[38:39], v6 offset:512
    s_add_u32 m0, s56, 0x0
    s_add_u32 s48, s50, 5
    s_and_b32 s48, s48, 7
    s_mul_i32 s49, s48, 196608
    s_lshl_b32 s48, s48, 7
    buffer_load_dwordx4 v11, s[20:23], s48 offen offset:0 lds
    s_waitcnt lgkmcnt(5)
    v_mfma_f32_16x16x32_bf16 v[116:119], v[56:59], v[156:159], v[116:119]
    ds_read_b128 v[164:167], v2 offset:2048
    v_mfma_f32_16x16x32_bf16 v[124:127], v[60:63], v[156:159], v[124:127]
    buffer_load_dwordx4 v12, s[20:23], s48 offen offset:1024 lds
    s_waitcnt lgkmcnt(1)
    v_mfma_f32_16x16x32_bf16 v[112:115], v[32:35], v[160:163], v[112:115]
    v_xor_b32 v3, 64, v2
    ds_read_b128 v[168:171], v3 offset:0
    ds_read_b64_tr_b16 v[40:41], v5 offset:4096
    ds_read_b64_tr_b16 v[42:43], v5 offset:4608
    ds_read_b64_tr_b16 v[44:45], v6 offset:4096
    v_mfma_f32_16x16x32_bf16 v[120:123], v[36:39], v[160:163], v[120:123]
    ds_read_b64_tr_b16 v[46:47], v6 offset:4608
    s_add_u32 m0, s57, 0x4000
    s_nop 0
    buffer_load_dwordx4 v13, s[24:27], s49 offen offset:0 lds
    s_waitcnt lgkmcnt(5)
    v_mfma_f32_16x16x32_bf16 v[116:119], v[32:35], v[164:167], v[116:119]
    ds_read_b128 v[172:175], v3 offset:2048
    v_mfma_f32_16x16x32_bf16 v[124:127], v[36:39], v[164:167], v[124:127]
    s_waitcnt lgkmcnt(1)
    v_mfma_f32_16x16x32_bf16 v[112:115], v[40:43], v[168:171], v[112:115]
    s_waitcnt vmcnt(6)
    s_barrier
    v_add_u32 v2, 0x8000, v2
    v_add_u32 v5, 0x8000, v5
    v_add_u32 v6, 0x8000, v6
    ds_read_b128 v[176:179], v2 offset:0
    ds_read_b64_tr_b16 v[48:49], v5 offset:0
    ds_read_b64_tr_b16 v[50:51], v5 offset:512
    ds_read_b64_tr_b16 v[52:53], v6 offset:0
    ds_read_b64_tr_b16 v[54:55], v6 offset:512
    s_add_u32 m0, s56, 0x8000
    s_add_u32 s48, s50, 6
    s_and_b32 s48, s48, 7
    v_mfma_f32_16x16x32_bf16 v[120:123], v[44:47], v[168:171], v[120:123]
    s_mul_i32 s49, s48, 196608
    s_lshl_b32 s48, s48, 7
    buffer_load_dwordx4 v11, s[20:23], s48 offen offset:0 lds
    s_and_b32 s89, s2, 7
    s_lshl_b32 s89, s89, 2
    s_bfe_u32 s38, s2, 0x20003
    s_add_u32 s89, s89, s38
    s_lshr_b32 s88, s2, 5
    s_lshr_b32 s62, s3, 2
    s_and_b32 s63, s3, 3
    s_waitcnt lgkmcnt(5)
    v_mfma_f32_16x16x32_bf16 v[116:119], v[40:43], v[172:175], v[116:119]
    ds_read_b128 v[180:183], v2 offset:2048
    buffer_load_dwordx4 v12, s[20:23], s48 offen offset:1024 lds
    s_cmp_eq_u32 s3, 0
    s_cselect_b32 s38, 0, 0x20000
    v_mov_b32 v22, s38
    v_mfma_f32_16x16x32_bf16 v[124:127], v[44:47], v[172:175], v[124:127]
    v_and_b32 v18, 15, v0
    v_lshlrev_b32 v18, 4, v18
    v_mov_b32 v21, v18
    v_lshrrev_b32 v104, 5, v0
    s_waitcnt lgkmcnt(1)
    v_mfma_f32_16x16x32_bf16 v[112:115], v[48:51], v[176:179], v[112:115]
    v_xor_b32 v3, 64, v2
    ds_read_b128 v[184:187], v3 offset:0
    ds_read_b64_tr_b16 v[56:57], v5 offset:4096
    ds_read_b64_tr_b16 v[58:59], v5 offset:4608
    ds_read_b64_tr_b16 v[60:61], v6 offset:4096
    ds_read_b64_tr_b16 v[62:63], v6 offset:4608
    s_add_u32 m0, s57, 0xc000
    s_nop 0
    v_mfma_f32_16x16x32_bf16 v[120:123], v[52:55], v[176:179], v[120:123]
    buffer_load_dwordx4 v13, s[24:27], s49 offen offset:0 lds
    v_lshl_add_u32 v18, v104, 8, v18
    v_mov_b32 v19, 0xdddddddd
    s_mov_b32 s74, 0x0000ffff
    s_mov_b32 s75, 0x0000ffff
    s_add_u32 s80, s14, 0x1100000
    s_addc_u32 s81, s15, 0
    s_mov_b32 s82, 0x18000
    s_waitcnt lgkmcnt(5)
    v_mfma_f32_16x16x32_bf16 v[116:119], v[48:51], v[180:183], v[116:119]
    ds_read_b128 v[188:191], v3 offset:2048
    s_mov_b32 s83, 0x20000
    s_mov_b32 s84, s100
    s_mov_b32 s85, s101
    s_mov_b32 s86, 0x100
    v_mfma_f32_16x16x32_bf16 v[124:127], v[52:55], v[180:183], v[124:127]
    s_mov_b32 s87, 0x20000
    s_lshl_b32 s73, s89, 16
    s_add_u32 s68, s14, s73
    s_addc_u32 s69, s15, 0
    s_waitcnt lgkmcnt(1)
    v_mfma_f32_16x16x32_bf16 v[112:115], v[56:59], v[184:187], v[112:115]
    s_waitcnt vmcnt(6)
    s_barrier
    v_add_u32 v2, 0x8000, v2
    v_add_u32 v5, 0x8000, v5
    v_add_u32 v6, 0x8000, v6
    ds_read_b128 v[192:195], v2 offset:0
    ds_read_b64_tr_b16 v[32:33], v5 offset:0
    ds_read_b64_tr_b16 v[34:35], v5 offset:512
    ds_read_b64_tr_b16 v[36:37], v6 offset:0
    ds_read_b64_tr_b16 v[38:39], v6 offset:512
    s_add_u32 m0, s56, 0x10000
    s_add_u32 s48, s50, 7
    s_and_b32 s48, s48, 7
    v_mfma_f32_16x16x32_bf16 v[120:123], v[60:63], v[184:187], v[120:123]
    s_mul_i32 s49, s48, 196608
    s_lshl_b32 s48, s48, 7
    buffer_load_dwordx4 v11, s[20:23], s48 offen offset:0 lds
    s_mov_b32 s70, 0x10000
    s_mov_b32 s71, 0x20000
    s_lshl_b32 s38, s63, 14
    s_add_u32 s38, s38, s73
    s_add_u32 s39, s38, 0x200000
    s_add_u32 s8, s14, s39
    s_addc_u32 s9, s15, 0
    s_waitcnt lgkmcnt(5)
    v_mfma_f32_16x16x32_bf16 v[116:119], v[56:59], v[188:191], v[116:119]
    ds_read_b128 v[196:199], v2 offset:2048
    buffer_load_dwordx4 v12, s[20:23], s48 offen offset:1024 lds
    s_mov_b32 s10, 0x4000
    s_mov_b32 s11, 0x20000
    s_add_u32 s39, s38, 0x400000
    v_mfma_f32_16x16x32_bf16 v[124:127], v[60:63], v[188:191], v[124:127]
    s_add_u32 s64, s14, s39
    s_addc_u32 s65, s15, 0
    s_mov_b32 s66, 0x4000
    s_mov_b32 s67, 0x20000
    s_waitcnt lgkmcnt(1)
    v_mfma_f32_16x16x32_bf16 v[112:115], v[32:35], v[192:195], v[112:115]
    v_xor_b32 v3, 64, v2
    ds_read_b128 v[200:203], v3 offset:0
    ds_read_b64_tr_b16 v[40:41], v5 offset:4096
    ds_read_b64_tr_b16 v[42:43], v5 offset:4608
    ds_read_b64_tr_b16 v[44:45], v6 offset:4096
    ds_read_b64_tr_b16 v[46:47], v6 offset:4608
    s_add_u32 m0, s57, 0x14000
    s_nop 0
    v_mfma_f32_16x16x32_bf16 v[120:123], v[36:39], v[192:195], v[120:123]
    buffer_load_dwordx4 v13, s[24:27], s49 offen offset:0 lds
    s_lshl_b32 s72, s88, 11
    s_lshl_b32 s39, s88, 3
    s_add_u32 s38, s3, s39
    s_lshl_b32 s38, s38, 5
    s_add_u32 s38, s38, s89
    s_lshl_b32 s61, s38, 10
    s_lshl_b32 s38, s62, 2
    s_waitcnt lgkmcnt(5)
    v_mfma_f32_16x16x32_bf16 v[116:119], v[32:35], v[196:199], v[116:119]
    ds_read_b128 v[204:207], v3 offset:2048
    s_add_u32 s39, s39, s38
    s_add_u32 s38, s63, 1
    s_and_b32 s38, s38, 3
    v_mfma_f32_16x16x32_bf16 v[124:127], v[36:39], v[196:199], v[124:127]
    s_add_u32 s38, s38, s39
    s_lshl_b32 s36, s38, 10
    s_add_u32 s38, s63, 2
    s_and_b32 s38, s38, 3
    s_waitcnt lgkmcnt(1)
    v_mfma_f32_16x16x32_bf16 v[112:115], v[40:43], v[200:203], v[112:115]
    s_waitcnt vmcnt(6)
    s_barrier
    v_add_u32 v2, 0xfffe0000, v2
    v_add_u32 v5, 0xfffe0000, v5
    v_add_u32 v6, 0xfffe0000, v6
    ds_read_b128 v[208:211], v2 offset:0
    ds_read_b64_tr_b16 v[48:49], v5 offset:0
    ds_read_b64_tr_b16 v[50:51], v5 offset:512
    ds_read_b64_tr_b16 v[52:53], v6 offset:0
    ds_read_b64_tr_b16 v[54:55], v6 offset:512
    s_add_u32 m0, s57, 0x18000
    s_add_u32 s48, s50, 0
    s_and_b32 s48, s48, 7
    s_mul_i32 s49, s48, 229376
    v_mfma_f32_16x16x32_bf16 v[120:123], v[44:47], v[200:203], v[120:123]
    s_add_u32 s49, s49, s52
    buffer_load_dwordx4 v14, s[40:43], s49 offen offset:0 lds
    s_add_u32 m0, s57, 0x1a000
    s_nop 0
    buffer_load_dwordx4 v14, s[44:47], s49 offen offset:0 lds
    s_add_u32 s38, s38, s39
    s_lshl_b32 s37, s38, 10
    s_add_u32 s38, s63, 3
    s_and_b32 s38, s38, 3
    s_add_u32 s38, s38, s39
    s_lshl_b32 s54, s38, 10
    s_add_u32 s38, s63, 4
    s_waitcnt lgkmcnt(5)
    v_mfma_f32_16x16x32_bf16 v[116:119], v[40:43], v[204:207], v[116:119]
    ds_read_b128 v[212:215], v2 offset:2048
    s_add_u32 m0, s57, 0x1c000
    s_add_u32 s48, s50, 1
    s_and_b32 s48, s48, 7
    s_mul_i32 s49, s48, 229376
    s_add_u32 s49, s49, s52
    buffer_load_dwordx4 v14, s[40:43], s49 offen offset:0 lds
    v_mfma_f32_16x16x32_bf16 v[124:127], v[44:47], v[204:207], v[124:127]
    s_and_b32 s38, s38, 3
    s_add_u32 s38, s38, s39
    s_lshl_b32 s55, s38, 10
    v_bfe_u32 v105, v0, 4, 1
    v_lshlrev_b32 v106, 2, v105
    v_and_b32 v107, 7, v0
    v_xor_b32 v106, v106, v107
    s_waitcnt lgkmcnt(1)
    v_mfma_f32_16x16x32_bf16 v[112:115], v[48:51], v[208:211], v[112:115]
    v_xor_b32 v3, 64, v2
    ds_read_b128 v[216:219], v3 offset:0
    ds_read_b64_tr_b16 v[56:57], v5 offset:4096
    ds_read_b64_tr_b16 v[58:59], v5 offset:4608
    ds_read_b64_tr_b16 v[60:61], v6 offset:4096
    ds_read_b64_tr_b16 v[62:63], v6 offset:4608
    s_add_u32 m0, s57, 0x1e000
    s_nop 0
    v_mfma_f32_16x16x32_bf16 v[120:123], v[52:55], v[208:211], v[120:123]
    buffer_load_dwordx4 v14, s[44:47], s49 offen offset:0 lds
    v_lshlrev_b32 v106, 4, v106
    v_lshrrev_b32 v107, 3, v0
    v_lshl_add_u32 v23, v107, 10, v106
    s_lshl_b32 s38, s62, 13
    v_add_u32 v24, s38, v23
    v_add_u32 v25, 14336, v24
    v_bfe_u32 v107, v0, 2, 2
    s_waitcnt lgkmcnt(5)
    v_mfma_f32_16x16x32_bf16 v[116:119], v[48:51], v[212:215], v[116:119]
    ds_read_b128 v[220:223], v3 offset:2048
    v_lshl_add_u32 v106, v104, 3, v107
    v_bfe_u32 v107, v0, 1, 1
    v_lshl_add_u32 v107, v105, 1, v107
    v_mfma_f32_16x16x32_bf16 v[124:127], v[52:55], v[212:215], v[124:127]
    v_bfe_u32 v108, v0, 3, 1
    v_lshl_add_u32 v107, v108, 2, v107
    v_lshlrev_b32 v107, 4, v107
    v_and_b32 v108, 1, v0
    s_waitcnt lgkmcnt(1)
    v_mfma_f32_16x16x32_bf16 v[112:115], v[56:59], v[216:219], v[112:115]
    s_waitcnt vmcnt(7)
    s_barrier
    v_add_u32 v2, 0x8000, v2
    v_add_u32 v5, 0x8000, v5
    v_add_u32 v6, 0x8000, v6
    ds_read_b128 v[224:227], v2 offset:0
    ds_read_b64_tr_b16 v[32:33], v5 offset:0
    ds_read_b64_tr_b16 v[34:35], v5 offset:512
    ds_read_b64_tr_b16 v[36:37], v6 offset:0
    ds_read_b64_tr_b16 v[38:39], v6 offset:512
    v_mfma_f32_16x16x32_bf16 v[120:123], v[60:63], v[216:219], v[120:123]
    v_lshl_add_u32 v107, v108, 3, v107
    v_lshl_add_u32 v107, v106, 7, v107
    s_lshl_b32 s16, s63, 12
    s_add_u32 s16, s16, 65536
    v_add_u32 v26, s16, v107
    v_xor_b32 v27, 64, v26
    s_lshl_b32 s38, s62, 10
    s_waitcnt lgkmcnt(5)
    v_mfma_f32_16x16x32_bf16 v[116:119], v[56:59], v[220:223], v[116:119]
    ds_read_b128 v[228:231], v2 offset:2048
    s_add_u32 s17, s16, s38
    s_and_b32 s53, s89, 3
    s_add_u32 s59, s53, s88
    v_mfma_f32_16x16x32_bf16 v[124:127], v[60:63], v[220:223], v[124:127]
    s_cmp_ge_u32 s59, 6
    s_cselect_b32 s38, 6, 0
    s_sub_u32 s59, s59, s38
    s_lshl_b32 s59, s59, 2
    s_waitcnt lgkmcnt(1)
    v_mfma_f32_16x16x32_bf16 v[112:115], v[32:35], v[224:227], v[112:115]
    v_xor_b32 v3, 64, v2
    ds_read_b128 v[232:235], v3 offset:0
    ds_read_b64_tr_b16 v[40:41], v5 offset:4096
    ds_read_b64_tr_b16 v[42:43], v5 offset:4608
    ds_read_b64_tr_b16 v[44:45], v6 offset:4096
    ds_read_b64_tr_b16 v[46:47], v6 offset:4608
    s_mov_b32 s38, 0x10ba7610
    v_mfma_f32_16x16x32_bf16 v[120:123], v[36:39], v[224:227], v[120:123]
    s_mov_b32 s39, 0xba76
    s_lshr_b64 s[38:39], s[38:39], s59
    s_and_b32 s99, s38, 0xffffff
    s_lshl_b32 s53, s53, 1
    s_add_u32 s59, s53, s88
    s_and_b32 s59, s59, 7
    s_waitcnt lgkmcnt(5)
    v_mfma_f32_16x16x32_bf16 v[116:119], v[32:35], v[228:231], v[116:119]
    ds_read_b128 v[236:239], v3 offset:2048
    s_lshl_b32 s59, s59, 2
    s_mov_b32 s38, 0xdc985432
    s_mov_b32 s39, s38
    v_mfma_f32_16x16x32_bf16 v[124:127], v[36:39], v[228:231], v[124:127]
    s_lshr_b64 s[38:39], s[38:39], s59
    s_lshl_b32 s98, s38, 24
    s_or_b32 s98, s98, s99
    s_waitcnt lgkmcnt(1)
    v_mfma_f32_16x16x32_bf16 v[112:115], v[40:43], v[232:235], v[112:115]
    s_waitcnt vmcnt(4)
    s_barrier
    v_add_u32 v2, 0x8000, v2
    v_add_u32 v5, 0x8000, v5
    v_add_u32 v6, 0x8000, v6
    ds_read_b128 v[240:243], v2 offset:0
    ds_read_b64_tr_b16 v[48:49], v5 offset:0
    ds_read_b64_tr_b16 v[50:51], v5 offset:512
    ds_read_b64_tr_b16 v[52:53], v6 offset:0
    ds_read_b64_tr_b16 v[54:55], v6 offset:512
    s_add_u32 m0, s57, 0x20000
    s_add_u32 s48, s50, 2
    s_and_b32 s48, s48, 7
    s_mul_i32 s49, s48, 229376
    v_mfma_f32_16x16x32_bf16 v[120:123], v[44:47], v[232:235], v[120:123]
    s_add_u32 s49, s49, s52
    buffer_load_dwordx4 v14, s[40:43], s49 offen offset:0 lds
    s_add_u32 m0, s57, 0x22000
    s_nop 0
    buffer_load_dwordx4 v14, s[44:47], s49 offen offset:0 lds
    s_lshr_b32 s99, s38, 8
    s_add_u32 s53, s61, 0xe00000
    s_lshl_b32 s59, s18, 4
    s_add_u32 s59, s59, s19
    s_lshl_b32 s59, s59, 7
    s_lshl_b32 s90, s19, 4
    s_waitcnt lgkmcnt(5)
    v_mfma_f32_16x16x32_bf16 v[116:119], v[40:43], v[236:239], v[116:119]
    ds_read_b128 v[244:247], v2 offset:2048
    s_add_u32 m0, s57, 0x24000
    s_add_u32 s48, s50, 3
    s_and_b32 s48, s48, 7
    s_mul_i32 s49, s48, 229376
    s_add_u32 s49, s49, s52
    buffer_load_dwordx4 v14, s[40:43], s49 offen offset:0 lds
    v_mfma_f32_16x16x32_bf16 v[124:127], v[44:47], v[236:239], v[124:127]
    s_add_u32 s90, s90, s18
    s_lshl_b32 s90, s90, 7
    s_add_u32 s90, s90, 65536
    s_lshr_b32 s38, s89, 2
    v_lshlrev_b32 v106, 3, v105
    v_add_u32 v106, s38, v106
    s_waitcnt lgkmcnt(1)
    v_mfma_f32_16x16x32_bf16 v[112:115], v[48:51], v[240:243], v[112:115]
    v_xor_b32 v3, 64, v2
    ds_read_b128 v[248:251], v3 offset:0
    ds_read_b64_tr_b16 v[56:57], v5 offset:4096
    ds_read_b64_tr_b16 v[58:59], v5 offset:4608
    ds_read_b64_tr_b16 v[60:61], v6 offset:4096
    ds_read_b64_tr_b16 v[62:63], v6 offset:4608
    s_add_u32 m0, s57, 0x26000
    s_nop 0
    v_mfma_f32_16x16x32_bf16 v[120:123], v[52:55], v[240:243], v[120:123]
    buffer_load_dwordx4 v14, s[44:47], s49 offen offset:0 lds
    s_lshr_b32 s39, s38, 1
    s_lshl_b32 s39, s39, 2
    s_and_b32 s38, s38, 1
    s_add_u32 s39, s39, s38
    s_add_u32 s39, s39, 1
    v_sub_u32 v107, s39, v106
    s_waitcnt lgkmcnt(5)
    v_mfma_f32_16x16x32_bf16 v[116:119], v[48:51], v[244:247], v[116:119]
    s_waitcnt vmcnt(4)
    s_barrier
    ds_read_b128 v[252:255], v3 offset:2048
    ds_read_b64_tr_b16 v[32:33], v7 offset:0
    ds_read_b64_tr_b16 v[34:35], v7 offset:512
    ds_read_b64_tr_b16 v[36:37], v7 offset:8192
    ds_read_b64_tr_b16 v[38:39], v7 offset:8704
    s_add_u32 m0, s57, 0x0
    s_add_u32 s48, s50, 4
    s_and_b32 s48, s48, 7
    s_mul_i32 s49, s48, 229376
    s_add_u32 s49, s49, s52
    v_mfma_f32_16x16x32_bf16 v[124:127], v[52:55], v[244:247], v[124:127]
    buffer_load_dwordx4 v14, s[40:43], s49 offen offset:0 lds
    s_add_u32 m0, s57, 0x2000
    s_nop 0
    buffer_load_dwordx4 v14, s[44:47], s49 offen offset:0 lds
    v_mul_i32_i24 v107, v107, v104
    v_add_u32 v106, v106, v107
    v_and_b32 v107, 15, v0
    v_lshl_add_u32 v106, v106, 4, v107
    v_lshlrev_b32 v106, 7, v106
    v_add_u32 v28, 65536, v106
    s_waitcnt lgkmcnt(5)
    v_mfma_f32_16x16x32_bf16 v[112:115], v[56:59], v[248:251], v[112:115]
    ds_read_b64_tr_b16 v[40:41], v8 offset:0
    ds_read_b64_tr_b16 v[42:43], v8 offset:512
    ds_read_b64_tr_b16 v[44:45], v8 offset:8192
    ds_read_b64_tr_b16 v[46:47], v8 offset:8704
    s_add_u32 m0, s57, 0x4000
    v_mfma_f32_16x16x32_bf16 v[120:123], v[60:63], v[248:251], v[120:123]
    s_add_u32 s48, s50, 5
    s_and_b32 s48, s48, 7
    s_mul_i32 s49, s48, 229376
    s_add_u32 s49, s49, s52
    buffer_load_dwordx4 v14, s[40:43], s49 offen offset:0 lds
    s_waitcnt lgkmcnt(8)
    v_mfma_f32_16x16x32_bf16 v[116:119], v[56:59], v[252:255], v[116:119]
    s_add_u32 m0, s57, 0x6000
    s_nop 0
    v_mfma_f32_16x16x32_bf16 v[124:127], v[60:63], v[252:255], v[124:127]
    buffer_load_dwordx4 v14, s[44:47], s49 offen offset:0 lds
    s_waitcnt lgkmcnt(4)
    v_mfma_f32_16x16x32_bf16 v[64:67], v[32:35], v[128:131], 0
    ds_read_b64_tr_b16 v[48:49], v7 offset:4096
    v_mfma_f32_16x16x32_bf16 v[72:75], v[36:39], v[128:131], 0
    ds_read_b64_tr_b16 v[50:51], v7 offset:4608
    s_waitcnt lgkmcnt(2)
    v_mfma_f32_16x16x32_bf16 v[80:83], v[40:43], v[128:131], 0
    ds_read_b64_tr_b16 v[52:53], v7 offset:12288
    v_mfma_f32_16x16x32_bf16 v[88:91], v[44:47], v[128:131], 0
    ds_read_b64_tr_b16 v[54:55], v7 offset:12800
    v_mfma_f32_16x16x32_bf16 v[68:71], v[32:35], v[132:135], 0
    ds_read_b64_tr_b16 v[56:57], v8 offset:4096
    ds_read_b64_tr_b16 v[58:59], v8 offset:4608
    v_mfma_f32_16x16x32_bf16 v[76:79], v[36:39], v[132:135], 0
    ds_read_b64_tr_b16 v[60:61], v8 offset:12288
    ds_read_b64_tr_b16 v[62:63], v8 offset:12800
    v_mfma_f32_16x16x32_bf16 v[84:87], v[40:43], v[132:135], 0
    v_mov_b32 v96, -1
    v_mov_b32 v97, -1
    v_mov_b32 v98, -1
    v_mov_b32 v99, -1
    buffer_store_dwordx4 v[96:99], v1, s[28:31], s53 offen sc1
    s_add_u32 s53, s59, 32768
    s_mov_b64 exec, 1
    buffer_store_dword v29, v22, s[80:83], s59 offen sc1
    buffer_store_dword v29, v22, s[80:83], s53 offen sc1
    buffer_store_dword v29, v22, s[80:83], s90 offen sc1
    s_mov_b64 exec, -1
    v_mfma_f32_16x16x32_bf16 v[92:95], v[44:47], v[132:135], 0
    s_waitcnt lgkmcnt(4)
    v_mfma_f32_16x16x32_bf16 v[64:67], v[48:51], v[136:139], v[64:67]
    ds_read_b64_tr_b16 v[32:33], v7 offset:16384
    ds_read_b64_tr_b16 v[34:35], v7 offset:16896
    ds_read_b64_tr_b16 v[36:37], v7 offset:24576
    ds_read_b64_tr_b16 v[38:39], v7 offset:25088
    v_mfma_f32_16x16x32_bf16 v[72:75], v[52:55], v[136:139], v[72:75]
    s_mov_b32 exec_lo, 0
    s_mov_b32 exec_hi, 0x80000000
    buffer_store_dwordx2 v[30:31], v29, s[28:31], s60 offen sc1
    s_mov_b64 exec, -1
    v_mul_f32 v112, s92, v112
    v_mul_f32 v113, s92, v113
    v_mul_f32 v114, s92, v114
    s_waitcnt lgkmcnt(4)
    v_mfma_f32_16x16x32_bf16 v[80:83], v[56:59], v[136:139], v[80:83]
    v_mul_f32 v115, s92, v115
    v_mul_f32 v116, s92, v116
    v_mul_f32 v117, s92, v117
    v_mul_f32 v118, s92, v118
    v_mfma_f32_16x16x32_bf16 v[88:91], v[60:63], v[136:139], v[88:91]
    v_mul_f32 v119, s92, v119
    v_mul_f32 v120, s92, v120
    v_mul_f32 v121, s92, v121
    v_mul_f32 v122, s92, v122
    v_mfma_f32_16x16x32_bf16 v[68:71], v[48:51], v[140:143], v[68:71]
    ds_read_b64_tr_b16 v[40:41], v8 offset:16384
    ds_read_b64_tr_b16 v[42:43], v8 offset:16896
    ds_read_b64_tr_b16 v[44:45], v8 offset:24576
    ds_read_b64_tr_b16 v[46:47], v8 offset:25088
    v_mfma_f32_16x16x32_bf16 v[76:79], v[52:55], v[140:143], v[76:79]
    v_mul_f32 v123, s92, v123
    v_mul_f32 v124, s92, v124
    v_mul_f32 v125, s92, v125
    v_mul_f32 v126, s92, v126
    v_mfma_f32_16x16x32_bf16 v[84:87], v[56:59], v[140:143], v[84:87]
    v_mul_f32 v127, s92, v127
    v_cvt_pk_bf16_f32 v112, v112, v113
    v_cvt_pk_bf16_f32 v113, v114, v115
    v_cvt_pk_bf16_f32 v114, v116, v117
    v_mfma_f32_16x16x32_bf16 v[92:95], v[60:63], v[140:143], v[92:95]
    v_cvt_pk_bf16_f32 v115, v118, v119
    v_cvt_pk_bf16_f32 v116, v120, v121
    v_cvt_pk_bf16_f32 v117, v122, v123
    s_waitcnt lgkmcnt(4)
    v_mfma_f32_16x16x32_bf16 v[64:67], v[32:35], v[144:147], v[64:67]
    ds_read_b64_tr_b16 v[48:49], v7 offset:20480
    ds_read_b64_tr_b16 v[50:51], v7 offset:20992
    ds_read_b64_tr_b16 v[52:53], v7 offset:28672
    v_mfma_f32_16x16x32_bf16 v[72:75], v[36:39], v[144:147], v[72:75]
    ds_read_b64_tr_b16 v[54:55], v7 offset:29184
    v_cvt_pk_bf16_f32 v118, v124, v125
    v_cvt_pk_bf16_f32 v119, v126, v127
    s_waitcnt lgkmcnt(4)
    v_mfma_f32_16x16x32_bf16 v[80:83], v[40:43], v[144:147], v[80:83]
    v_permlane16_swap_b32 v112, v114
    v_permlane16_swap_b32 v113, v115
    v_permlane16_swap_b32 v116, v118
    v_mfma_f32_16x16x32_bf16 v[88:91], v[44:47], v[144:147], v[88:91]
    v_permlane16_swap_b32 v117, v119
    v_mfma_f32_16x16x32_bf16 v[68:71], v[32:35], v[148:151], v[68:71]
    ds_read_b64_tr_b16 v[56:57], v8 offset:20480
    ds_read_b64_tr_b16 v[58:59], v8 offset:20992
    v_mfma_f32_16x16x32_bf16 v[76:79], v[36:39], v[148:151], v[76:79]
    ds_read_b64_tr_b16 v[60:61], v8 offset:28672
    ds_read_b64_tr_b16 v[62:63], v8 offset:29184
    v_mfma_f32_16x16x32_bf16 v[84:87], v[40:43], v[148:151], v[84:87]
    buffer_store_dwordx4 v[112:115], v1, s[28:31], s91 offen sc1
    v_mfma_f32_16x16x32_bf16 v[92:95], v[44:47], v[148:151], v[92:95]
    s_waitcnt lgkmcnt(4)
    v_mfma_f32_16x16x32_bf16 v[64:67], v[48:51], v[152:155], v[64:67]
    s_waitcnt vmcnt(10)
    s_barrier
    v_add_u32 v7, 0x8000, v7
    v_add_u32 v8, 0x8000, v8
    ds_read_b64_tr_b16 v[32:33], v7 offset:0
    ds_read_b64_tr_b16 v[34:35], v7 offset:512
    v_mfma_f32_16x16x32_bf16 v[72:75], v[52:55], v[152:155], v[72:75]
    ds_read_b64_tr_b16 v[36:37], v7 offset:8192
    ds_read_b64_tr_b16 v[38:39], v7 offset:8704
    s_add_u32 m0, s57, 0x8000
    s_add_u32 s48, s50, 6
    s_waitcnt lgkmcnt(4)
    v_mfma_f32_16x16x32_bf16 v[80:83], v[56:59], v[152:155], v[80:83]
    s_and_b32 s48, s48, 7
    s_mul_i32 s49, s48, 229376
    s_add_u32 s49, s49, s52
    buffer_load_dwordx4 v14, s[40:43], s49 offen offset:0 lds
    v_mfma_f32_16x16x32_bf16 v[88:91], v[60:63], v[152:155], v[88:91]
    buffer_store_dwordx4 v[116:119], v1, s[28:31], s94 offen sc1
    v_mfma_f32_16x16x32_bf16 v[68:71], v[48:51], v[156:159], v[68:71]
    ds_read_b64_tr_b16 v[40:41], v8 offset:0
    ds_read_b64_tr_b16 v[42:43], v8 offset:512
    v_mfma_f32_16x16x32_bf16 v[76:79], v[52:55], v[156:159], v[76:79]
    ds_read_b64_tr_b16 v[44:45], v8 offset:8192
    ds_read_b64_tr_b16 v[46:47], v8 offset:8704
    v_mfma_f32_16x16x32_bf16 v[84:87], v[56:59], v[156:159], v[84:87]
    s_mov_b32 s92, 0xbfb8aa3b
    s_mov_b32 s93, s92
    s_mov_b32 s12, 1.0
    s_mov_b32 s13, 1.0
    s_add_u32 s32, s14, 0x600000
    s_addc_u32 s33, s15, 0
    s_mov_b32 s34, 0x700000
    s_mov_b32 s35, 0x20000
    v_mfma_f32_16x16x32_bf16 v[92:95], v[60:63], v[156:159], v[92:95]
    s_waitcnt lgkmcnt(4)
    v_mfma_f32_16x16x32_bf16 v[64:67], v[32:35], v[160:163], v[64:67]
    ds_read_b64_tr_b16 v[48:49], v7 offset:4096
    ds_read_b64_tr_b16 v[50:51], v7 offset:4608
    v_mfma_f32_16x16x32_bf16 v[72:75], v[36:39], v[160:163], v[72:75]
    ds_read_b64_tr_b16 v[52:53], v7 offset:12288
    ds_read_b64_tr_b16 v[54:55], v7 offset:12800
    s_waitcnt lgkmcnt(4)
    v_mfma_f32_16x16x32_bf16 v[80:83], v[40:43], v[160:163], v[80:83]
    s_add_u32 m0, s57, 0xa000
    s_nop 0
    v_mfma_f32_16x16x32_bf16 v[88:91], v[44:47], v[160:163], v[88:91]
    buffer_load_dwordx4 v14, s[44:47], s49 offen offset:0 lds
    v_mfma_f32_16x16x32_bf16 v[68:71], v[32:35], v[164:167], v[68:71]
    ds_read_b64_tr_b16 v[56:57], v8 offset:4096
    v_mfma_f32_16x16x32_bf16 v[76:79], v[36:39], v[164:167], v[76:79]
    ds_read_b64_tr_b16 v[58:59], v8 offset:4608
    v_mfma_f32_16x16x32_bf16 v[84:87], v[40:43], v[164:167], v[84:87]
    ds_read_b64_tr_b16 v[60:61], v8 offset:12288
    v_mfma_f32_16x16x32_bf16 v[92:95], v[44:47], v[164:167], v[92:95]
    ds_read_b64_tr_b16 v[62:63], v8 offset:12800
    s_waitcnt lgkmcnt(4)
    v_mfma_f32_16x16x32_bf16 v[64:67], v[48:51], v[168:171], v[64:67]
    ds_read_b64_tr_b16 v[32:33], v7 offset:16384
    ds_read_b64_tr_b16 v[34:35], v7 offset:16896
    ds_read_b64_tr_b16 v[36:37], v7 offset:24576
    v_mfma_f32_16x16x32_bf16 v[72:75], v[52:55], v[168:171], v[72:75]
    ds_read_b64_tr_b16 v[38:39], v7 offset:25088
    s_add_u32 m0, s57, 0xc000
    s_add_u32 s48, s50, 7
    s_waitcnt lgkmcnt(4)
    v_mfma_f32_16x16x32_bf16 v[80:83], v[56:59], v[168:171], v[80:83]
    s_and_b32 s48, s48, 7
    s_mul_i32 s49, s48, 229376
    s_add_u32 s49, s49, s52
    v_mfma_f32_16x16x32_bf16 v[88:91], v[60:63], v[168:171], v[88:91]
    buffer_load_dwordx4 v14, s[40:43], s49 offen offset:0 lds
    v_mfma_f32_16x16x32_bf16 v[68:71], v[48:51], v[172:175], v[68:71]
    ds_read_b64_tr_b16 v[40:41], v8 offset:16384
    v_mfma_f32_16x16x32_bf16 v[76:79], v[52:55], v[172:175], v[76:79]
    ds_read_b64_tr_b16 v[42:43], v8 offset:16896
    v_mfma_f32_16x16x32_bf16 v[84:87], v[56:59], v[172:175], v[84:87]
    ds_read_b64_tr_b16 v[44:45], v8 offset:24576
    v_mfma_f32_16x16x32_bf16 v[92:95], v[60:63], v[172:175], v[92:95]
    ds_read_b64_tr_b16 v[46:47], v8 offset:25088
    s_waitcnt lgkmcnt(4)
    v_mfma_f32_16x16x32_bf16 v[64:67], v[32:35], v[176:179], v[64:67]
    ds_read_b64_tr_b16 v[48:49], v7 offset:20480
    ds_read_b64_tr_b16 v[50:51], v7 offset:20992
    v_mfma_f32_16x16x32_bf16 v[72:75], v[36:39], v[176:179], v[72:75]
    ds_read_b64_tr_b16 v[52:53], v7 offset:28672
    ds_read_b64_tr_b16 v[54:55], v7 offset:29184
    s_waitcnt lgkmcnt(4)
    v_mfma_f32_16x16x32_bf16 v[80:83], v[40:43], v[176:179], v[80:83]
    s_add_u32 m0, s57, 0xe000
    s_nop 0
    v_mfma_f32_16x16x32_bf16 v[88:91], v[44:47], v[176:179], v[88:91]
    buffer_load_dwordx4 v14, s[44:47], s49 offen offset:0 lds
    v_mfma_f32_16x16x32_bf16 v[68:71], v[32:35], v[180:183], v[68:71]
    ds_read_b64_tr_b16 v[56:57], v8 offset:20480
    v_mfma_f32_16x16x32_bf16 v[76:79], v[36:39], v[180:183], v[76:79]
    ds_read_b64_tr_b16 v[58:59], v8 offset:20992
    v_mfma_f32_16x16x32_bf16 v[84:87], v[40:43], v[180:183], v[84:87]
    ds_read_b64_tr_b16 v[60:61], v8 offset:28672
    v_mfma_f32_16x16x32_bf16 v[92:95], v[44:47], v[180:183], v[92:95]
    ds_read_b64_tr_b16 v[62:63], v8 offset:29184
    s_waitcnt lgkmcnt(4)
    v_mfma_f32_16x16x32_bf16 v[64:67], v[48:51], v[184:187], v[64:67]
    s_waitcnt vmcnt(6)
    s_barrier
    s_lshl_b32 s38, s19, 4
    v_mov_b32 v20, 1
    s_mov_b64 exec, 1
    buffer_atomic_add v20, v22, s[84:87], s38 offen sc1
    s_mov_b64 exec, -1
    v_add_u32 v7, 0xfffe0000, v7
    v_add_u32 v8, 0xfffe0000, v8
    ds_read_b64_tr_b16 v[32:33], v7 offset:0
    v_mfma_f32_16x16x32_bf16 v[72:75], v[52:55], v[184:187], v[72:75]
    ds_read_b64_tr_b16 v[34:35], v7 offset:512
    ds_read_b64_tr_b16 v[36:37], v7 offset:8192
    ds_read_b64_tr_b16 v[38:39], v7 offset:8704
    s_waitcnt lgkmcnt(4)
    v_mfma_f32_16x16x32_bf16 v[80:83], v[56:59], v[184:187], v[80:83]
    s_add_u32 m0, s57, 0x10000
    s_add_u32 s48, s50, 0
    s_and_b32 s48, s48, 7
    v_mfma_f32_16x16x32_bf16 v[88:91], v[60:63], v[184:187], v[88:91]
    s_mul_i32 s49, s48, 229376
    s_add_u32 s49, s49, s97
    buffer_load_dwordx4 v14, s[40:43], s49 offen offset:0 lds
    v_mfma_f32_16x16x32_bf16 v[68:71], v[48:51], v[188:191], v[68:71]
    ds_read_b64_tr_b16 v[40:41], v8 offset:0
    v_mfma_f32_16x16x32_bf16 v[76:79], v[52:55], v[188:191], v[76:79]
    ds_read_b64_tr_b16 v[42:43], v8 offset:512
    v_mfma_f32_16x16x32_bf16 v[84:87], v[56:59], v[188:191], v[84:87]
    ds_read_b64_tr_b16 v[44:45], v8 offset:8192
    v_mfma_f32_16x16x32_bf16 v[92:95], v[60:63], v[188:191], v[92:95]
    ds_read_b64_tr_b16 v[46:47], v8 offset:8704
    s_waitcnt lgkmcnt(4)
    v_mfma_f32_16x16x32_bf16 v[64:67], v[32:35], v[192:195], v[64:67]
    ds_read_b64_tr_b16 v[48:49], v7 offset:4096
    ds_read_b64_tr_b16 v[50:51], v7 offset:4608
    v_mfma_f32_16x16x32_bf16 v[72:75], v[36:39], v[192:195], v[72:75]
    ds_read_b64_tr_b16 v[52:53], v7 offset:12288
    ds_read_b64_tr_b16 v[54:55], v7 offset:12800
    s_waitcnt lgkmcnt(4)
    v_mfma_f32_16x16x32_bf16 v[80:83], v[40:43], v[192:195], v[80:83]
    s_add_u32 m0, s57, 0x12000
    s_nop 0
    v_mfma_f32_16x16x32_bf16 v[88:91], v[44:47], v[192:195], v[88:91]
    buffer_load_dwordx4 v14, s[44:47], s49 offen offset:0 lds
    v_mfma_f32_16x16x32_bf16 v[68:71], v[32:35], v[196:199], v[68:71]
    ds_read_b64_tr_b16 v[56:57], v8 offset:4096
    v_mfma_f32_16x16x32_bf16 v[76:79], v[36:39], v[196:199], v[76:79]
    ds_read_b64_tr_b16 v[58:59], v8 offset:4608
    v_mfma_f32_16x16x32_bf16 v[84:87], v[40:43], v[196:199], v[84:87]
    ds_read_b64_tr_b16 v[60:61], v8 offset:12288
    v_mfma_f32_16x16x32_bf16 v[92:95], v[44:47], v[196:199], v[92:95]
    ds_read_b64_tr_b16 v[62:63], v8 offset:12800
    s_waitcnt lgkmcnt(4)
    v_mfma_f32_16x16x32_bf16 v[64:67], v[48:51], v[200:203], v[64:67]
    ds_read_b64_tr_b16 v[32:33], v7 offset:16384
    ds_read_b64_tr_b16 v[34:35], v7 offset:16896
    ds_read_b64_tr_b16 v[36:37], v7 offset:24576
    v_mfma_f32_16x16x32_bf16 v[72:75], v[52:55], v[200:203], v[72:75]
    ds_read_b64_tr_b16 v[38:39], v7 offset:25088
    s_add_u32 m0, s57, 0x14000
    s_add_u32 s48, s50, 1
    s_waitcnt lgkmcnt(4)
    v_mfma_f32_16x16x32_bf16 v[80:83], v[56:59], v[200:203], v[80:83]
    s_and_b32 s48, s48, 7
    s_mul_i32 s49, s48, 229376
    s_add_u32 s49, s49, s97
    v_mfma_f32_16x16x32_bf16 v[88:91], v[60:63], v[200:203], v[88:91]
    buffer_load_dwordx4 v14, s[40:43], s49 offen offset:0 lds
    v_mfma_f32_16x16x32_bf16 v[68:71], v[48:51], v[204:207], v[68:71]
    ds_read_b64_tr_b16 v[40:41], v8 offset:16384
    v_mfma_f32_16x16x32_bf16 v[76:79], v[52:55], v[204:207], v[76:79]
    ds_read_b64_tr_b16 v[42:43], v8 offset:16896
    v_mfma_f32_16x16x32_bf16 v[84:87], v[56:59], v[204:207], v[84:87]
    ds_read_b64_tr_b16 v[44:45], v8 offset:24576
    v_mfma_f32_16x16x32_bf16 v[92:95], v[60:63], v[204:207], v[92:95]
    ds_read_b64_tr_b16 v[46:47], v8 offset:25088
    s_waitcnt lgkmcnt(4)
    v_mfma_f32_16x16x32_bf16 v[64:67], v[32:35], v[208:211], v[64:67]
    ds_read_b64_tr_b16 v[48:49], v7 offset:20480
    ds_read_b64_tr_b16 v[50:51], v7 offset:20992
    v_mfma_f32_16x16x32_bf16 v[72:75], v[36:39], v[208:211], v[72:75]
    ds_read_b64_tr_b16 v[52:53], v7 offset:28672
    ds_read_b64_tr_b16 v[54:55], v7 offset:29184
    s_waitcnt lgkmcnt(4)
    v_mfma_f32_16x16x32_bf16 v[80:83], v[40:43], v[208:211], v[80:83]
    s_add_u32 m0, s57, 0x16000
    s_nop 0
    v_mfma_f32_16x16x32_bf16 v[88:91], v[44:47], v[208:211], v[88:91]
    buffer_load_dwordx4 v14, s[44:47], s49 offen offset:0 lds
    v_mfma_f32_16x16x32_bf16 v[68:71], v[32:35], v[212:215], v[68:71]
    ds_read_b64_tr_b16 v[56:57], v8 offset:20480
    v_mfma_f32_16x16x32_bf16 v[76:79], v[36:39], v[212:215], v[76:79]
    ds_read_b64_tr_b16 v[58:59], v8 offset:20992
    v_mfma_f32_16x16x32_bf16 v[84:87], v[40:43], v[212:215], v[84:87]
    ds_read_b64_tr_b16 v[60:61], v8 offset:28672
    v_mfma_f32_16x16x32_bf16 v[92:95], v[44:47], v[212:215], v[92:95]
    ds_read_b64_tr_b16 v[62:63], v8 offset:29184
    s_waitcnt lgkmcnt(4)
    v_mfma_f32_16x16x32_bf16 v[64:67], v[48:51], v[216:219], v[64:67]
    s_waitcnt vmcnt(5)
    s_barrier
    v_mov_b32 v20, 1
    s_mov_b64 exec, 1
    buffer_store_dword v20, v22, s[80:83], s90 offen sc1
    s_mov_b64 exec, -1
    v_add_u32 v7, 0x8000, v7
    v_add_u32 v8, 0x8000, v8
    ds_read_b64_tr_b16 v[32:33], v7 offset:0
    v_mfma_f32_16x16x32_bf16 v[72:75], v[52:55], v[216:219], v[72:75]
    ds_read_b64_tr_b16 v[34:35], v7 offset:512
    ds_read_b64_tr_b16 v[36:37], v7 offset:8192
    ds_read_b64_tr_b16 v[38:39], v7 offset:8704
    s_waitcnt lgkmcnt(4)
    v_mfma_f32_16x16x32_bf16 v[80:83], v[56:59], v[216:219], v[80:83]
    s_add_u32 m0, s57, 0x18000
    s_add_u32 s48, s50, 2
    s_and_b32 s48, s48, 7
    v_mfma_f32_16x16x32_bf16 v[88:91], v[60:63], v[216:219], v[88:91]
    s_mul_i32 s49, s48, 229376
    s_add_u32 s49, s49, s97
    buffer_load_dwordx4 v14, s[40:43], s49 offen offset:0 lds
    v_mfma_f32_16x16x32_bf16 v[68:71], v[48:51], v[220:223], v[68:71]
    ds_read_b64_tr_b16 v[40:41], v8 offset:0
    v_mfma_f32_16x16x32_bf16 v[76:79], v[52:55], v[220:223], v[76:79]
    ds_read_b64_tr_b16 v[42:43], v8 offset:512
    v_mfma_f32_16x16x32_bf16 v[84:87], v[56:59], v[220:223], v[84:87]
    ds_read_b64_tr_b16 v[44:45], v8 offset:8192
    v_mfma_f32_16x16x32_bf16 v[92:95], v[60:63], v[220:223], v[92:95]
    ds_read_b64_tr_b16 v[46:47], v8 offset:8704
    s_waitcnt lgkmcnt(4)
    v_mfma_f32_16x16x32_bf16 v[64:67], v[32:35], v[224:227], v[64:67]
    ds_read_b64_tr_b16 v[48:49], v7 offset:4096
    ds_read_b64_tr_b16 v[50:51], v7 offset:4608
    v_mfma_f32_16x16x32_bf16 v[72:75], v[36:39], v[224:227], v[72:75]
    ds_read_b64_tr_b16 v[52:53], v7 offset:12288
    ds_read_b64_tr_b16 v[54:55], v7 offset:12800
    s_waitcnt lgkmcnt(4)
    v_mfma_f32_16x16x32_bf16 v[80:83], v[40:43], v[224:227], v[80:83]
    s_add_u32 m0, s57, 0x1a000
    s_nop 0
    v_mfma_f32_16x16x32_bf16 v[88:91], v[44:47], v[224:227], v[88:91]
    buffer_load_dwordx4 v14, s[44:47], s49 offen offset:0 lds
    v_mfma_f32_16x16x32_bf16 v[68:71], v[32:35], v[228:231], v[68:71]
    ds_read_b64_tr_b16 v[56:57], v8 offset:4096
    v_mfma_f32_16x16x32_bf16 v[76:79], v[36:39], v[228:231], v[76:79]
    ds_read_b64_tr_b16 v[58:59], v8 offset:4608
    v_mfma_f32_16x16x32_bf16 v[84:87], v[40:43], v[228:231], v[84:87]
    ds_read_b64_tr_b16 v[60:61], v8 offset:12288
    v_mfma_f32_16x16x32_bf16 v[92:95], v[44:47], v[228:231], v[92:95]
    ds_read_b64_tr_b16 v[62:63], v8 offset:12800
    s_waitcnt lgkmcnt(4)
    v_mfma_f32_16x16x32_bf16 v[64:67], v[48:51], v[232:235], v[64:67]
    ds_read_b64_tr_b16 v[32:33], v7 offset:16384
    ds_read_b64_tr_b16 v[34:35], v7 offset:16896
    ds_read_b64_tr_b16 v[36:37], v7 offset:24576
    v_mfma_f32_16x16x32_bf16 v[72:75], v[52:55], v[232:235], v[72:75]
    ds_read_b64_tr_b16 v[38:39], v7 offset:25088
    s_add_u32 m0, s57, 0x1c000
    s_add_u32 s48, s50, 3
    s_waitcnt lgkmcnt(4)
    v_mfma_f32_16x16x32_bf16 v[80:83], v[56:59], v[232:235], v[80:83]
    s_and_b32 s48, s48, 7
    s_mul_i32 s49, s48, 229376
    s_add_u32 s49, s49, s97
    v_mfma_f32_16x16x32_bf16 v[88:91], v[60:63], v[232:235], v[88:91]
    buffer_load_dwordx4 v14, s[40:43], s49 offen offset:0 lds
    v_mfma_f32_16x16x32_bf16 v[68:71], v[48:51], v[236:239], v[68:71]
    ds_read_b64_tr_b16 v[40:41], v8 offset:16384
    v_mfma_f32_16x16x32_bf16 v[76:79], v[52:55], v[236:239], v[76:79]
    ds_read_b64_tr_b16 v[42:43], v8 offset:16896
    v_mfma_f32_16x16x32_bf16 v[84:87], v[56:59], v[236:239], v[84:87]
    ds_read_b64_tr_b16 v[44:45], v8 offset:24576
    v_mfma_f32_16x16x32_bf16 v[92:95], v[60:63], v[236:239], v[92:95]
    ds_read_b64_tr_b16 v[46:47], v8 offset:25088
    s_waitcnt lgkmcnt(4)
    v_mfma_f32_16x16x32_bf16 v[64:67], v[32:35], v[240:243], v[64:67]
    ds_read_b64_tr_b16 v[48:49], v7 offset:20480
    ds_read_b64_tr_b16 v[50:51], v7 offset:20992
    v_mfma_f32_16x16x32_bf16 v[72:75], v[36:39], v[240:243], v[72:75]
    ds_read_b64_tr_b16 v[52:53], v7 offset:28672
    ds_read_b64_tr_b16 v[54:55], v7 offset:29184
    s_waitcnt lgkmcnt(4)
    v_mfma_f32_16x16x32_bf16 v[80:83], v[40:43], v[240:243], v[80:83]
    s_add_u32 m0, s57, 0x1e000
    s_nop 0
    v_mfma_f32_16x16x32_bf16 v[88:91], v[44:47], v[240:243], v[88:91]
    buffer_load_dwordx4 v14, s[44:47], s49 offen offset:0 lds
    v_mfma_f32_16x16x32_bf16 v[68:71], v[32:35], v[244:247], v[68:71]
    ds_read_b64_tr_b16 v[56:57], v8 offset:20480
    v_mfma_f32_16x16x32_bf16 v[76:79], v[36:39], v[244:247], v[76:79]
    ds_read_b64_tr_b16 v[58:59], v8 offset:20992
    v_mfma_f32_16x16x32_bf16 v[84:87], v[40:43], v[244:247], v[84:87]
    ds_read_b64_tr_b16 v[60:61], v8 offset:28672
    v_mfma_f32_16x16x32_bf16 v[92:95], v[44:47], v[244:247], v[92:95]
    ds_read_b64_tr_b16 v[62:63], v8 offset:29184
    s_waitcnt lgkmcnt(4)
    v_mfma_f32_16x16x32_bf16 v[64:67], v[48:51], v[248:251], v[64:67]
    s_waitcnt vmcnt(5)
    s_barrier
    v_add_u32 v7, 0x8000, v7
    v_add_u32 v8, 0x8000, v8
    ds_read_b64_tr_b16 v[32:33], v7 offset:0
    v_mfma_f32_16x16x32_bf16 v[72:75], v[52:55], v[248:251], v[72:75]
    ds_read_b64_tr_b16 v[34:35], v7 offset:512
    ds_read_b64_tr_b16 v[36:37], v7 offset:8192
    ds_read_b64_tr_b16 v[38:39], v7 offset:8704
    s_waitcnt lgkmcnt(4)
    v_mfma_f32_16x16x32_bf16 v[80:83], v[56:59], v[248:251], v[80:83]
    s_add_u32 m0, s57, 0x20000
    s_add_u32 s48, s50, 4
    s_and_b32 s48, s48, 7
    v_mfma_f32_16x16x32_bf16 v[88:91], v[60:63], v[248:251], v[88:91]
    s_mul_i32 s49, s48, 229376
    s_add_u32 s49, s49, s97
    buffer_load_dwordx4 v14, s[40:43], s49 offen offset:0 lds
    v_mfma_f32_16x16x32_bf16 v[68:71], v[48:51], v[252:255], v[68:71]
    ds_read_b64_tr_b16 v[40:41], v8 offset:0
    v_mfma_f32_16x16x32_bf16 v[76:79], v[52:55], v[252:255], v[76:79]
    ds_read_b64_tr_b16 v[42:43], v8 offset:512
    v_mfma_f32_16x16x32_bf16 v[84:87], v[56:59], v[252:255], v[84:87]
    ds_read_b64_tr_b16 v[44:45], v8 offset:8192
    v_mfma_f32_16x16x32_bf16 v[92:95], v[60:63], v[252:255], v[92:95]
    ds_read_b64_tr_b16 v[46:47], v8 offset:8704
    s_waitcnt lgkmcnt(4)
    v_mfma_f32_16x16x32_bf16 v[96:99], v[32:35], v[128:131], 0
    ds_read_b64_tr_b16 v[48:49], v7 offset:4096
    ds_read_b64_tr_b16 v[50:51], v7 offset:4608
    v_mfma_f32_16x16x32_bf16 v[104:107], v[36:39], v[128:131], 0
    ds_read_b64_tr_b16 v[52:53], v7 offset:12288
    ds_read_b64_tr_b16 v[54:55], v7 offset:12800
    s_waitcnt lgkmcnt(4)
    v_mfma_f32_16x16x32_bf16 v[112:115], v[40:43], v[128:131], 0
    s_add_u32 m0, s57, 0x22000
    s_nop 0
    v_mfma_f32_16x16x32_bf16 v[120:123], v[44:47], v[128:131], 0
    buffer_load_dwordx4 v14, s[44:47], s49 offen offset:0 lds
    v_mfma_f32_16x16x32_bf16 v[100:103], v[32:35], v[132:135], 0
    ds_read_b64_tr_b16 v[56:57], v8 offset:4096
    v_mfma_f32_16x16x32_bf16 v[108:111], v[36:39], v[132:135], 0
    ds_read_b64_tr_b16 v[58:59], v8 offset:4608
    v_mfma_f32_16x16x32_bf16 v[116:119], v[40:43], v[132:135], 0
    ds_read_b64_tr_b16 v[60:61], v8 offset:12288
    v_mfma_f32_16x16x32_bf16 v[124:127], v[44:47], v[132:135], 0
    ds_read_b64_tr_b16 v[62:63], v8 offset:12800
    s_waitcnt lgkmcnt(4)
    v_mfma_f32_16x16x32_bf16 v[96:99], v[48:51], v[136:139], v[96:99]
    ds_read_b64_tr_b16 v[32:33], v7 offset:16384
    ds_read_b64_tr_b16 v[34:35], v7 offset:16896
    ds_read_b64_tr_b16 v[36:37], v7 offset:24576
    v_mfma_f32_16x16x32_bf16 v[104:107], v[52:55], v[136:139], v[104:107]
    ds_read_b64_tr_b16 v[38:39], v7 offset:25088
    s_add_u32 m0, s57, 0x24000
    s_add_u32 s48, s50, 5
    s_waitcnt lgkmcnt(4)
    v_mfma_f32_16x16x32_bf16 v[112:115], v[56:59], v[136:139], v[112:115]
    s_and_b32 s48, s48, 7
    s_mul_i32 s49, s48, 229376
    s_add_u32 s49, s49, s97
    v_mfma_f32_16x16x32_bf16 v[120:123], v[60:63], v[136:139], v[120:123]
    buffer_load_dwordx4 v14, s[40:43], s49 offen offset:0 lds
    v_mfma_f32_16x16x32_bf16 v[100:103], v[48:51], v[140:143], v[100:103]
    ds_read_b64_tr_b16 v[40:41], v8 offset:16384
    ds_read_b64_tr_b16 v[42:43], v8 offset:16896
    ds_read_b64_tr_b16 v[44:45], v8 offset:24576
    ds_read_b64_tr_b16 v[46:47], v8 offset:25088
    v_mfma_f32_16x16x32_bf16 v[108:111], v[52:55], v[140:143], v[108:111]
    v_mul_f32 v128, s92, v64
    v_mul_f32 v129, s92, v65
    v_mul_f32 v130, s92, v66
    v_mul_f32 v131, s92, v67
    v_mfma_f32_16x16x32_bf16 v[116:119], v[56:59], v[140:143], v[116:119]
    v_mul_f32 v132, s92, v68
    v_mul_f32 v133, s92, v69
    v_mul_f32 v134, s92, v70
    v_mul_f32 v135, s92, v71
    v_mfma_f32_16x16x32_bf16 v[124:127], v[60:63], v[140:143], v[124:127]
    v_exp_f32 v128, v128
    s_waitcnt lgkmcnt(4)
    v_mfma_f32_16x16x32_bf16 v[96:99], v[32:35], v[144:147], v[96:99]
    ds_read_b64_tr_b16 v[48:49], v7 offset:20480
    ds_read_b64_tr_b16 v[50:51], v7 offset:20992
    ds_read_b64_tr_b16 v[52:53], v7 offset:28672
    ds_read_b64_tr_b16 v[54:55], v7 offset:29184
    s_add_u32 m0, s57, 0x26000
    v_mfma_f32_16x16x32_bf16 v[104:107], v[36:39], v[144:147], v[104:107]
    s_nop 0
    buffer_load_dwordx4 v14, s[44:47], s49 offen offset:0 lds
    v_exp_f32 v129, v129
    v_exp_f32 v130, v130
    v_exp_f32 v131, v131
    s_waitcnt lgkmcnt(4)
    v_mfma_f32_16x16x32_bf16 v[112:115], v[40:43], v[144:147], v[112:115]
    v_exp_f32 v132, v132
    v_exp_f32 v133, v133
    v_exp_f32 v134, v134
    v_exp_f32 v135, v135
    v_mul_f32 v64, v72, v64
    v_mfma_f32_16x16x32_bf16 v[120:123], v[44:47], v[144:147], v[120:123]
    v_mul_f32 v65, v73, v65
    s_mov_b32 s28, s76
    s_mov_b32 s29, s77
    s_mov_b32 s30, 0x1c0000
    s_mov_b32 s31, 0x20000
    s_lshl_b32 s94, s2, 3
    s_add_u32 s94, s94, s3
    s_mul_i32 s96, s94, 896
    v_lshlrev_b32 v29, 7, v0
    s_mov_b64 exec, 0x7f
    buffer_load_dword v30, v29, s[28:31], s96 offen
    s_mov_b32 s28, s78
    s_mov_b32 s29, s79
    s_mov_b32 s30, 0x80000
    s_mov_b32 s31, 0x20000
    s_lshl_b32 s96, s94, 8
    s_mov_b64 exec, 3
    buffer_load_dword v30, v29, s[28:31], s96 offen
    s_mov_b64 exec, -1
    v_mfma_f32_16x16x32_bf16 v[100:103], v[32:35], v[148:151], v[100:103]
    ds_read_b64_tr_b16 v[56:57], v8 offset:20480
    ds_read_b64_tr_b16 v[58:59], v8 offset:20992
    ds_read_b64_tr_b16 v[60:61], v8 offset:28672
    ds_read_b64_tr_b16 v[62:63], v8 offset:29184
    v_mfma_f32_16x16x32_bf16 v[108:111], v[36:39], v[148:151], v[108:111]
    v_mul_f32 v66, v74, v66
    v_mul_f32 v67, v75, v67
    v_mul_f32 v68, v76, v68
    v_mul_f32 v69, v77, v69
    v_mfma_f32_16x16x32_bf16 v[116:119], v[40:43], v[148:151], v[116:119]
    v_mul_f32 v70, v78, v70
    v_mul_f32 v71, v79, v71
    v_add_f32 v128, 1.0, v128
    v_add_f32 v129, 1.0, v129
    v_mfma_f32_16x16x32_bf16 v[124:127], v[44:47], v[148:151], v[124:127]
    v_add_f32 v130, 1.0, v130
    s_waitcnt lgkmcnt(4)
    v_mfma_f32_16x16x32_bf16 v[96:99], v[48:51], v[152:155], v[96:99]
    s_waitcnt vmcnt(6)
    s_barrier
    v_add_u32 v7, 0x8000, v7
    v_add_u32 v8, 0x8000, v8
    ds_read_b64_tr_b16 v[32:33], v7 offset:0
    ds_read_b64_tr_b16 v[34:35], v7 offset:512
    ds_read_b64_tr_b16 v[36:37], v7 offset:8192
    ds_read_b64_tr_b16 v[38:39], v7 offset:8704
    v_mfma_f32_16x16x32_bf16 v[104:107], v[52:55], v[152:155], v[104:107]
    s_add_u32 m0, s57, 0x0
    s_add_u32 s48, s50, 6
    s_and_b32 s48, s48, 7
    s_mul_i32 s49, s48, 229376
    s_add_u32 s49, s49, s97
    buffer_load_dwordx4 v14, s[40:43], s49 offen offset:0 lds
    s_waitcnt lgkmcnt(4)
    v_mfma_f32_16x16x32_bf16 v[112:115], v[56:59], v[152:155], v[112:115]
    v_add_f32 v131, 1.0, v131
    v_add_f32 v132, 1.0, v132
    v_add_f32 v133, 1.0, v133
    v_add_f32 v134, 1.0, v134
    v_add_f32 v135, 1.0, v135
    v_rcp_f32 v128, v128
    v_mfma_f32_16x16x32_bf16 v[120:123], v[60:63], v[152:155], v[120:123]
    v_rcp_f32 v129, v129
    v_rcp_f32 v130, v130
    v_rcp_f32 v131, v131
    v_mfma_f32_16x16x32_bf16 v[100:103], v[48:51], v[156:159], v[100:103]
    ds_read_b64_tr_b16 v[40:41], v8 offset:0
    ds_read_b64_tr_b16 v[42:43], v8 offset:512
    ds_read_b64_tr_b16 v[44:45], v8 offset:8192
    ds_read_b64_tr_b16 v[46:47], v8 offset:8704
    v_mfma_f32_16x16x32_bf16 v[108:111], v[52:55], v[156:159], v[108:111]
    v_rcp_f32 v132, v132
    v_rcp_f32 v133, v133
    v_rcp_f32 v134, v134
    v_rcp_f32 v135, v135
    v_mfma_f32_16x16x32_bf16 v[116:119], v[56:59], v[156:159], v[116:119]
    s_nop 0
    v_mul_f32 v64, v128, v64
    v_mul_f32 v65, v129, v65
    v_mul_f32 v66, v130, v66
    v_mfma_f32_16x16x32_bf16 v[124:127], v[60:63], v[156:159], v[124:127]
    v_mul_f32 v67, v131, v67
    s_waitcnt lgkmcnt(4)
    v_mfma_f32_16x16x32_bf16 v[96:99], v[32:35], v[160:163], v[96:99]
    ds_read_b64_tr_b16 v[48:49], v7 offset:4096
    ds_read_b64_tr_b16 v[50:51], v7 offset:4608
    ds_read_b64_tr_b16 v[52:53], v7 offset:12288
    ds_read_b64_tr_b16 v[54:55], v7 offset:12800
    v_mfma_f32_16x16x32_bf16 v[104:107], v[36:39], v[160:163], v[104:107]
    s_add_u32 m0, s57, 0x2000
    s_nop 0
    buffer_load_dwordx4 v14, s[44:47], s49 offen offset:0 lds
    v_mul_f32 v68, v132, v68
    s_waitcnt lgkmcnt(4)
    v_mfma_f32_16x16x32_bf16 v[112:115], v[40:43], v[160:163], v[112:115]
    v_mul_f32 v69, v133, v69
    v_mul_f32 v70, v134, v70
    v_mul_f32 v71, v135, v71
    v_cvt_pk_bf16_f32 v64, v64, v65
    v_mfma_f32_16x16x32_bf16 v[120:123], v[44:47], v[160:163], v[120:123]
    v_cvt_pk_bf16_f32 v65, v66, v67
    v_cvt_pk_bf16_f32 v66, v68, v69
    v_cvt_pk_bf16_f32 v67, v70, v71
    s_nop 0
    v_mfma_f32_16x16x32_bf16 v[100:103], v[32:35], v[164:167], v[100:103]
    ds_read_b64_tr_b16 v[56:57], v8 offset:4096
    ds_read_b64_tr_b16 v[58:59], v8 offset:4608
    ds_read_b64_tr_b16 v[60:61], v8 offset:12288
    ds_read_b64_tr_b16 v[62:63], v8 offset:12800
    v_mfma_f32_16x16x32_bf16 v[108:111], v[36:39], v[164:167], v[108:111]
    v_permlane16_swap_b32 v64, v66
    v_permlane16_swap_b32 v65, v67
    buffer_store_dwordx4 v[64:67], v1, s[32:35], s95 offen offset:0 sc1
    v_mul_f32 v128, s92, v80
    v_mfma_f32_16x16x32_bf16 v[116:119], v[40:43], v[164:167], v[116:119]
    v_mul_f32 v129, s92, v81
    v_mul_f32 v130, s92, v82
    v_mul_f32 v131, s92, v83
    v_mul_f32 v132, s92, v84
    v_mfma_f32_16x16x32_bf16 v[124:127], v[44:47], v[164:167], v[124:127]
    v_mul_f32 v133, s92, v85
    s_waitcnt lgkmcnt(4)
    v_mfma_f32_16x16x32_bf16 v[96:99], v[48:51], v[168:171], v[96:99]
    ds_read_b64_tr_b16 v[32:33], v7 offset:16384
    ds_read_b64_tr_b16 v[34:35], v7 offset:16896
    ds_read_b64_tr_b16 v[36:37], v7 offset:24576
    ds_read_b64_tr_b16 v[38:39], v7 offset:25088
    s_add_u32 m0, s57, 0x4000
    s_add_u32 s48, s50, 7
    v_mfma_f32_16x16x32_bf16 v[104:107], v[52:55], v[168:171], v[104:107]
    s_and_b32 s48, s48, 7
    s_mul_i32 s49, s48, 229376
    s_add_u32 s49, s49, s97
    buffer_load_dwordx4 v14, s[40:43], s49 offen offset:0 lds
    v_mul_f32 v134, s92, v86
    v_mul_f32 v135, s92, v87
    s_waitcnt lgkmcnt(4)
    v_mfma_f32_16x16x32_bf16 v[112:115], v[56:59], v[168:171], v[112:115]
    v_exp_f32 v128, v128
    v_exp_f32 v129, v129
    v_exp_f32 v130, v130
    v_exp_f32 v131, v131
    v_exp_f32 v132, v132
    v_exp_f32 v133, v133
    v_mfma_f32_16x16x32_bf16 v[120:123], v[60:63], v[168:171], v[120:123]
    v_exp_f32 v134, v134
    v_and_b32 v3, 31, v0
    v_cmp_eq_u32 s[20:21], 16, v3
    v_mov_b32 v3, 0x3f803f80
    v_mfma_f32_16x16x32_bf16 v[100:103], v[48:51], v[172:175], v[100:103]
    ds_read_b64_tr_b16 v[40:41], v8 offset:16384
    ds_read_b64_tr_b16 v[42:43], v8 offset:16896
    ds_read_b64_tr_b16 v[44:45], v8 offset:24576
    ds_read_b64_tr_b16 v[46:47], v8 offset:25088
    v_mfma_f32_16x16x32_bf16 v[108:111], v[52:55], v[172:175], v[108:111]
    v_exp_f32 v135, v135
    v_mul_f32 v80, v88, v80
    v_mul_f32 v81, v89, v81
    v_mul_f32 v82, v90, v82
    v_mfma_f32_16x16x32_bf16 v[116:119], v[56:59], v[172:175], v[116:119]
    v_mul_f32 v83, v91, v83
    v_mul_f32 v84, v92, v84
    v_mul_f32 v85, v93, v85
    v_mul_f32 v86, v94, v86
    v_mfma_f32_16x16x32_bf16 v[124:127], v[60:63], v[172:175], v[124:127]
    v_mul_f32 v87, v95, v87
    s_nop 0
    v_cndmask_b32 v152, 0, v3, s[20:21]
    v_mov_b32 v153, v152
    s_waitcnt lgkmcnt(4)
    v_mfma_f32_16x16x32_bf16 v[96:99], v[32:35], v[176:179], v[96:99]
    ds_read_b64_tr_b16 v[48:49], v7 offset:20480
    ds_read_b64_tr_b16 v[50:51], v7 offset:20992
    ds_read_b64_tr_b16 v[52:53], v7 offset:28672
    ds_read_b64_tr_b16 v[54:55], v7 offset:29184
    s_add_u32 m0, s57, 0x6000
    v_mfma_f32_16x16x32_bf16 v[104:107], v[36:39], v[176:179], v[104:107]
    s_nop 0
    buffer_load_dwordx4 v14, s[44:47], s49 offen offset:0 lds
    v_add_f32 v128, 1.0, v128
    v_add_f32 v129, 1.0, v129
    v_add_f32 v130, 1.0, v130
    s_waitcnt lgkmcnt(4)
    v_mfma_f32_16x16x32_bf16 v[112:115], v[40:43], v[176:179], v[112:115]
    v_add_f32 v131, 1.0, v131
    v_add_f32 v132, 1.0, v132
    v_add_f32 v133, 1.0, v133
    v_add_f32 v134, 1.0, v134
    v_add_f32 v135, 1.0, v135
    v_mfma_f32_16x16x32_bf16 v[120:123], v[44:47], v[176:179], v[120:123]
    v_rcp_f32 v128, v128
    v_mov_b32 v154, v152
    v_mov_b32 v155, v152
    v_mov_b32 v156, v152
    v_mfma_f32_16x16x32_bf16 v[100:103], v[32:35], v[180:183], v[100:103]
    ds_read_b64_tr_b16 v[56:57], v8 offset:20480
    ds_read_b64_tr_b16 v[58:59], v8 offset:20992
    ds_read_b64_tr_b16 v[60:61], v8 offset:28672
    ds_read_b64_tr_b16 v[62:63], v8 offset:29184
    v_mfma_f32_16x16x32_bf16 v[108:111], v[36:39], v[180:183], v[108:111]
    v_rcp_f32 v129, v129
    v_rcp_f32 v130, v130
    v_rcp_f32 v131, v131
    v_rcp_f32 v132, v132
    v_mfma_f32_16x16x32_bf16 v[116:119], v[40:43], v[180:183], v[116:119]
    v_rcp_f32 v133, v133
    v_rcp_f32 v134, v134
    v_rcp_f32 v135, v135
    s_nop 0
    v_mfma_f32_16x16x32_bf16 v[124:127], v[44:47], v[180:183], v[124:127]
    v_mul_f32 v80, v128, v80
    v_mov_b32 v157, v152
    v_mov_b32 v158, v152
    v_mov_b32 v159, v152
    s_waitcnt lgkmcnt(4)
    v_mfma_f32_16x16x32_bf16 v[96:99], v[48:51], v[184:187], v[96:99]
    s_waitcnt vmcnt(7)
    s_barrier
    v_add_u32 v7, 0x8000, v7
    v_add_u32 v8, 0x8000, v8
    ds_read_b64_tr_b16 v[32:33], v7 offset:0
    ds_read_b64_tr_b16 v[34:35], v7 offset:512
    ds_read_b64_tr_b16 v[36:37], v7 offset:8192
    v_mfma_f32_16x16x32_bf16 v[104:107], v[52:55], v[184:187], v[104:107]
    ds_read_b64_tr_b16 v[38:39], v7 offset:8704
    v_mul_f32 v81, v129, v81
    v_mul_f32 v82, v130, v82
    v_mul_f32 v83, v131, v83
    v_mul_f32 v84, v132, v84
    s_waitcnt lgkmcnt(4)
    v_mfma_f32_16x16x32_bf16 v[112:115], v[56:59], v[184:187], v[112:115]
    v_mul_f32 v85, v133, v85
    v_mul_f32 v86, v134, v86
    v_mul_f32 v87, v135, v87
    v_cvt_pk_bf16_f32 v80, v80, v81
    v_cvt_pk_bf16_f32 v81, v82, v83
    v_mfma_f32_16x16x32_bf16 v[120:123], v[60:63], v[184:187], v[120:123]
    v_mov_b32 v160, v152
    v_mov_b32 v161, v152
    v_mov_b32 v162, v152
    v_mfma_f32_16x16x32_bf16 v[100:103], v[48:51], v[188:191], v[100:103]
    ds_read_b64_tr_b16 v[40:41], v8 offset:0
    ds_read_b64_tr_b16 v[42:43], v8 offset:512
    ds_read_b64_tr_b16 v[44:45], v8 offset:8192
    ds_read_b64_tr_b16 v[46:47], v8 offset:8704
    v_mfma_f32_16x16x32_bf16 v[108:111], v[52:55], v[188:191], v[108:111]
    v_cvt_pk_bf16_f32 v82, v84, v85
    v_cvt_pk_bf16_f32 v83, v86, v87
    s_nop 0
    v_permlane16_swap_b32 v80, v82
    v_mfma_f32_16x16x32_bf16 v[116:119], v[56:59], v[188:191], v[116:119]
    v_permlane16_swap_b32 v81, v83
    buffer_store_dwordx4 v[80:83], v1, s[32:35], s95 offen offset:1024 sc1
    v_mov_b32 v163, v152
    v_mov_b32 v164, v152
    v_mfma_f32_16x16x32_bf16 v[124:127], v[60:63], v[188:191], v[124:127]
    v_mov_b32 v165, v152
    s_waitcnt lgkmcnt(4)
    v_mfma_f32_16x16x32_bf16 v[96:99], v[32:35], v[192:195], v[96:99]
    ds_read_b64_tr_b16 v[48:49], v7 offset:4096
    ds_read_b64_tr_b16 v[50:51], v7 offset:4608
    v_mfma_f32_16x16x32_bf16 v[104:107], v[36:39], v[192:195], v[104:107]
    ds_read_b64_tr_b16 v[52:53], v7 offset:12288
    ds_read_b64_tr_b16 v[54:55], v7 offset:12800
    s_waitcnt lgkmcnt(4)
    v_mfma_f32_16x16x32_bf16 v[112:115], v[40:43], v[192:195], v[112:115]
    v_mov_b32 v166, v152
    v_mov_b32 v167, v152
    v_mfma_f32_16x16x32_bf16 v[120:123], v[44:47], v[192:195], v[120:123]
    v_mfma_f32_16x16x32_bf16 v[100:103], v[32:35], v[196:199], v[100:103]
    ds_read_b64_tr_b16 v[56:57], v8 offset:4096
    v_mfma_f32_16x16x32_bf16 v[108:111], v[36:39], v[196:199], v[108:111]
    ds_read_b64_tr_b16 v[58:59], v8 offset:4608
    v_mfma_f32_16x16x32_bf16 v[116:119], v[40:43], v[196:199], v[116:119]
    ds_read_b64_tr_b16 v[60:61], v8 offset:12288
    v_mfma_f32_16x16x32_bf16 v[124:127], v[44:47], v[196:199], v[124:127]
    ds_read_b64_tr_b16 v[62:63], v8 offset:12800
    s_waitcnt lgkmcnt(4)
    v_mfma_f32_16x16x32_bf16 v[96:99], v[48:51], v[200:203], v[96:99]
    ds_read_b64_tr_b16 v[32:33], v7 offset:16384
    v_mfma_f32_16x16x32_bf16 v[104:107], v[52:55], v[200:203], v[104:107]
    ds_read_b64_tr_b16 v[34:35], v7 offset:16896
    s_waitcnt lgkmcnt(2)
    v_mfma_f32_16x16x32_bf16 v[112:115], v[56:59], v[200:203], v[112:115]
    ds_read_b64_tr_b16 v[36:37], v7 offset:24576
    v_mfma_f32_16x16x32_bf16 v[120:123], v[60:63], v[200:203], v[120:123]
    ds_read_b64_tr_b16 v[38:39], v7 offset:25088
    v_mfma_f32_16x16x32_bf16 v[100:103], v[48:51], v[204:207], v[100:103]
    ds_read_b64_tr_b16 v[40:41], v8 offset:16384
    ds_read_b64_tr_b16 v[42:43], v8 offset:16896
    v_mfma_f32_16x16x32_bf16 v[108:111], v[52:55], v[204:207], v[108:111]
    ds_read_b64_tr_b16 v[44:45], v8 offset:24576
    ds_read_b64_tr_b16 v[46:47], v8 offset:25088
    v_mfma_f32_16x16x32_bf16 v[116:119], v[56:59], v[204:207], v[116:119]
    buffer_load_dword v20, v21, s[84:87], 0 offen sc1
    v_mfma_f32_16x16x32_bf16 v[124:127], v[60:63], v[204:207], v[124:127]
    s_waitcnt lgkmcnt(4)
    v_mfma_f32_16x16x32_bf16 v[96:99], v[32:35], v[208:211], v[96:99]
    ds_read_b64_tr_b16 v[48:49], v7 offset:20480
    v_mfma_f32_16x16x32_bf16 v[104:107], v[36:39], v[208:211], v[104:107]
    ds_read_b64_tr_b16 v[50:51], v7 offset:20992
    s_waitcnt lgkmcnt(2)
    v_mfma_f32_16x16x32_bf16 v[112:115], v[40:43], v[208:211], v[112:115]
    ds_read_b64_tr_b16 v[52:53], v7 offset:28672
    v_mfma_f32_16x16x32_bf16 v[120:123], v[44:47], v[208:211], v[120:123]
    ds_read_b64_tr_b16 v[54:55], v7 offset:29184
    v_mfma_f32_16x16x32_bf16 v[100:103], v[32:35], v[212:215], v[100:103]
    ds_read_b64_tr_b16 v[56:57], v8 offset:20480
    v_mfma_f32_16x16x32_bf16 v[108:111], v[36:39], v[212:215], v[108:111]
    ds_read_b64_tr_b16 v[58:59], v8 offset:20992
    v_mfma_f32_16x16x32_bf16 v[116:119], v[40:43], v[212:215], v[116:119]
    ds_read_b64_tr_b16 v[60:61], v8 offset:28672
    v_mfma_f32_16x16x32_bf16 v[124:127], v[44:47], v[212:215], v[124:127]
    ds_read_b64_tr_b16 v[62:63], v8 offset:29184
    s_waitcnt lgkmcnt(4)
    v_mfma_f32_16x16x32_bf16 v[96:99], v[48:51], v[216:219], v[96:99]
    s_waitcnt vmcnt(2)
    s_waitcnt lgkmcnt(0)
    s_barrier
    v_add_u32 v7, 0xfffe0000, v7
    v_add_u32 v8, 0xfffe0000, v8
    v_mfma_f32_16x16x32_bf16 v[104:107], v[52:55], v[216:219], v[104:107]
    ds_read_b64_tr_b16 v[32:33], v7 offset:0
    ds_read_b64_tr_b16 v[34:35], v7 offset:512
    v_mfma_f32_16x16x32_bf16 v[112:115], v[56:59], v[216:219], v[112:115]
    ds_read_b64_tr_b16 v[36:37], v7 offset:8192
    ds_read_b64_tr_b16 v[38:39], v7 offset:8704
    v_mfma_f32_16x16x32_bf16 v[120:123], v[60:63], v[216:219], v[120:123]
    v_mfma_f32_16x16x32_bf16 v[100:103], v[48:51], v[220:223], v[100:103]
    ds_read_b64_tr_b16 v[40:41], v8 offset:0
    v_mfma_f32_16x16x32_bf16 v[108:111], v[52:55], v[220:223], v[108:111]
    ds_read_b64_tr_b16 v[42:43], v8 offset:512
    v_mfma_f32_16x16x32_bf16 v[116:119], v[56:59], v[220:223], v[116:119]
    ds_read_b64_tr_b16 v[44:45], v8 offset:8192
    v_mfma_f32_16x16x32_bf16 v[124:127], v[60:63], v[220:223], v[124:127]
    ds_read_b64_tr_b16 v[46:47], v8 offset:8704
    s_waitcnt lgkmcnt(4)
    v_mfma_f32_16x16x32_bf16 v[96:99], v[32:35], v[224:227], v[96:99]
    ds_read_b64_tr_b16 v[48:49], v7 offset:4096
    ds_read_b64_tr_b16 v[50:51], v7 offset:4608
    v_mfma_f32_16x16x32_bf16 v[104:107], v[36:39], v[224:227], v[104:107]
    ds_read_b64_tr_b16 v[52:53], v7 offset:12288
    ds_read_b64_tr_b16 v[54:55], v7 offset:12800
    s_waitcnt lgkmcnt(4)
    v_mfma_f32_16x16x32_bf16 v[112:115], v[40:43], v[224:227], v[112:115]
    s_waitcnt vmcnt(0)
    v_cmp_le_u32 vcc, 16, v20
    s_mov_b32 s38, 0x8000
    s_cmp_eq_u64 vcc, -1
    s_cbranch_scc1 KF_SB_P_OK
KF_SB_P:
    s_sleep 12
    buffer_load_dword v20, v21, s[84:87], 0 offen sc1
    s_sub_u32 s38, s38, 1
    s_waitcnt vmcnt(0)
    v_cmp_le_u32 vcc, 16, v20
    s_cselect_b32 s39, 1, 0
    s_cmp_eq_u64 vcc, -1
    s_cselect_b32 s39, 1, s39
    s_cmp_eq_u32 s39, 0
    s_cbranch_scc1 KF_SB_P
KF_SB_P_OK:
    v_mov_b32 v21, v28
    buffer_load_dword v20, v21, s[80:83], 0 offen sc1
    v_mfma_f32_16x16x32_bf16 v[120:123], v[44:47], v[224:227], v[120:123]
    v_mfma_f32_16x16x32_bf16 v[100:103], v[32:35], v[228:231], v[100:103]
    ds_read_b64_tr_b16 v[56:57], v8 offset:4096
    v_mfma_f32_16x16x32_bf16 v[108:111], v[36:39], v[228:231], v[108:111]
    ds_read_b64_tr_b16 v[58:59], v8 offset:4608
    v_mfma_f32_16x16x32_bf16 v[116:119], v[40:43], v[228:231], v[116:119]
    ds_read_b64_tr_b16 v[60:61], v8 offset:12288
    v_mfma_f32_16x16x32_bf16 v[124:127], v[44:47], v[228:231], v[124:127]
    ds_read_b64_tr_b16 v[62:63], v8 offset:12800
    s_waitcnt lgkmcnt(4)
    v_mfma_f32_16x16x32_bf16 v[96:99], v[48:51], v[232:235], v[96:99]
    ds_read_b64_tr_b16 v[32:33], v7 offset:16384
    v_mfma_f32_16x16x32_bf16 v[104:107], v[52:55], v[232:235], v[104:107]
    ds_read_b64_tr_b16 v[34:35], v7 offset:16896
    s_waitcnt lgkmcnt(2)
    v_mfma_f32_16x16x32_bf16 v[112:115], v[56:59], v[232:235], v[112:115]
    ds_read_b64_tr_b16 v[36:37], v7 offset:24576
    v_mfma_f32_16x16x32_bf16 v[120:123], v[60:63], v[232:235], v[120:123]
    ds_read_b64_tr_b16 v[38:39], v7 offset:25088
    v_mfma_f32_16x16x32_bf16 v[100:103], v[48:51], v[236:239], v[100:103]
    ds_read_b64_tr_b16 v[40:41], v8 offset:16384
    v_mfma_f32_16x16x32_bf16 v[108:111], v[52:55], v[236:239], v[108:111]
    ds_read_b64_tr_b16 v[42:43], v8 offset:16896
    v_mfma_f32_16x16x32_bf16 v[116:119], v[56:59], v[236:239], v[116:119]
    ds_read_b64_tr_b16 v[44:45], v8 offset:24576
    v_mfma_f32_16x16x32_bf16 v[124:127], v[60:63], v[236:239], v[124:127]
    ds_read_b64_tr_b16 v[46:47], v8 offset:25088
    s_waitcnt lgkmcnt(4)
    v_mfma_f32_16x16x32_bf16 v[96:99], v[32:35], v[240:243], v[96:99]
    ds_read_b64_tr_b16 v[48:49], v7 offset:20480
    v_mfma_f32_16x16x32_bf16 v[104:107], v[36:39], v[240:243], v[104:107]
    ds_read_b64_tr_b16 v[50:51], v7 offset:20992
    s_waitcnt lgkmcnt(2)
    v_mfma_f32_16x16x32_bf16 v[112:115], v[40:43], v[240:243], v[112:115]
    ds_read_b64_tr_b16 v[52:53], v7 offset:28672
    v_mfma_f32_16x16x32_bf16 v[120:123], v[44:47], v[240:243], v[120:123]
    ds_read_b64_tr_b16 v[54:55], v7 offset:29184
    v_mfma_f32_16x16x32_bf16 v[100:103], v[32:35], v[244:247], v[100:103]
    ds_read_b64_tr_b16 v[56:57], v8 offset:20480
    ds_read_b64_tr_b16 v[58:59], v8 offset:20992
    v_mfma_f32_16x16x32_bf16 v[108:111], v[36:39], v[244:247], v[108:111]
    ds_read_b64_tr_b16 v[60:61], v8 offset:28672
    ds_read_b64_tr_b16 v[62:63], v8 offset:29184
    v_mfma_f32_16x16x32_bf16 v[116:119], v[40:43], v[244:247], v[116:119]
    s_waitcnt vmcnt(0)
    v_cmp_le_u32 vcc, 1, v20
    s_mov_b32 s38, 0x8000
    s_cmp_eq_u64 vcc, -1
    s_cbranch_scc1 KF_SQ_P_OK
KF_SQ_P:
    s_sleep 4
    buffer_load_dword v20, v21, s[80:83], 0 offen sc1
    s_sub_u32 s38, s38, 1
    s_waitcnt vmcnt(0)
    v_cmp_le_u32 vcc, 1, v20
    s_cselect_b32 s39, 1, 0
    s_cmp_eq_u64 vcc, -1
    s_cselect_b32 s39, 1, s39
    s_cmp_eq_u32 s39, 0
    s_cbranch_scc1 KF_SQ_P
KF_SQ_P_OK:
    buffer_load_dwordx4 v[128:131], v1, s[68:71], s36 offen sc1
    buffer_load_dwordx4 v[144:147], v1, s[8:11], s72 offen sc1
    buffer_load_dwordx4 v[132:135], v1, s[68:71], s37 offen sc1
    v_mfma_f32_16x16x32_bf16 v[124:127], v[44:47], v[244:247], v[124:127]
    s_waitcnt lgkmcnt(4)
    v_mfma_f32_16x16x32_bf16 v[96:99], v[48:51], v[248:251], v[96:99]
    v_mfma_f32_16x16x32_bf16 v[104:107], v[52:55], v[248:251], v[104:107]
    s_waitcnt lgkmcnt(0)
    v_mfma_f32_16x16x32_bf16 v[112:115], v[56:59], v[248:251], v[112:115]
    v_mfma_f32_16x16x32_bf16 v[120:123], v[60:63], v[248:251], v[120:123]
    v_mfma_f32_16x16x32_bf16 v[100:103], v[48:51], v[252:255], v[100:103]
    v_mfma_f32_16x16x32_bf16 v[108:111], v[52:55], v[252:255], v[108:111]
    v_mfma_f32_16x16x32_bf16 v[116:119], v[56:59], v[252:255], v[116:119]
    v_mfma_f32_16x16x32_bf16 v[124:127], v[60:63], v[252:255], v[124:127]
    s_setprio 3
    buffer_load_dwordx4 v[136:139], v1, s[68:71], s54 offen sc1
    buffer_load_dwordx4 v[140:143], v1, s[68:71], s55 offen sc1
    s_mov_b64 exec, s[74:75]
    buffer_load_dwordx4 v[152:155], v18, s[64:67], s72 offen sc1
    buffer_load_dwordx4 v[156:159], v18, s[64:67], s72 offen offset:512 sc1
    s_mov_b64 exec, -1
    s_add_u32 s72, s72, 1024
    s_and_b32 s72, s72, 0x3fff
    s_nop 10
    v_pk_mul_f32 v[32:33], v[96:97], s[92:93]
    v_pk_mul_f32 v[34:35], v[98:99], s[92:93]
    v_pk_mul_f32 v[36:37], v[100:101], s[92:93]
    v_pk_mul_f32 v[38:39], v[102:103], s[92:93]
    v_exp_f32 v32, v32
    v_exp_f32 v33, v33
    v_exp_f32 v34, v34
    v_exp_f32 v35, v35
    v_exp_f32 v36, v36
    v_exp_f32 v37, v37
    v_exp_f32 v38, v38
    v_exp_f32 v39, v39
    v_pk_mul_f32 v[40:41], v[112:113], s[92:93]
    v_pk_mul_f32 v[42:43], v[114:115], s[92:93]
    v_pk_mul_f32 v[44:45], v[116:117], s[92:93]
    v_pk_mul_f32 v[46:47], v[118:119], s[92:93]
    v_exp_f32 v40, v40
    v_exp_f32 v41, v41
    v_exp_f32 v42, v42
    v_exp_f32 v43, v43
    v_exp_f32 v44, v44
    v_exp_f32 v45, v45
    v_exp_f32 v46, v46
    v_exp_f32 v47, v47
    v_pk_mul_f32 v[96:97], v[96:97], v[104:105]
    v_pk_mul_f32 v[98:99], v[98:99], v[106:107]
    v_pk_mul_f32 v[100:101], v[100:101], v[108:109]
    v_pk_mul_f32 v[102:103], v[102:103], v[110:111]
    v_pk_add_f32 v[32:33], v[32:33], s[12:13]
    v_pk_add_f32 v[34:35], v[34:35], s[12:13]
    v_pk_add_f32 v[36:37], v[36:37], s[12:13]
    v_pk_add_f32 v[38:39], v[38:39], s[12:13]
    v_rcp_f32 v32, v32
    v_rcp_f32 v33, v33
    v_rcp_f32 v34, v34
    v_rcp_f32 v35, v35
    v_rcp_f32 v36, v36
    v_rcp_f32 v37, v37
    v_rcp_f32 v38, v38
    v_rcp_f32 v39, v39
    buffer_load_dwordx4 v[148:151], v1, s[8:11], s72 offen sc1
    s_mov_b64 exec, s[74:75]
    buffer_load_dwordx4 v[160:163], v18, s[64:67], s72 offen sc1
    buffer_load_dwordx4 v[164:167], v18, s[64:67], s72 offen offset:512 sc1
    s_mov_b64 exec, -1
    s_add_u32 s72, s72, 1024
    s_and_b32 s72, s72, 0x3fff
    v_pk_mul_f32 v[112:113], v[112:113], v[120:121]
    v_pk_mul_f32 v[114:115], v[114:115], v[122:123]
    v_pk_mul_f32 v[116:117], v[116:117], v[124:125]
    v_pk_mul_f32 v[118:119], v[118:119], v[126:127]
    v_pk_add_f32 v[40:41], v[40:41], s[12:13]
    v_pk_add_f32 v[42:43], v[42:43], s[12:13]
    v_pk_add_f32 v[44:45], v[44:45], s[12:13]
    v_pk_add_f32 v[46:47], v[46:47], s[12:13]
    v_rcp_f32 v40, v40
    v_rcp_f32 v41, v41
    v_rcp_f32 v42, v42
    v_rcp_f32 v43, v43
    v_rcp_f32 v44, v44
    v_rcp_f32 v45, v45
    v_rcp_f32 v46, v46
    v_rcp_f32 v47, v47
    v_pk_mul_f32 v[96:97], v[96:97], v[32:33]
    v_pk_mul_f32 v[98:99], v[98:99], v[34:35]
    v_pk_mul_f32 v[100:101], v[100:101], v[36:37]
    v_pk_mul_f32 v[102:103], v[102:103], v[38:39]
    v_cvt_pk_bf16_f32 v96, v96, v97
    v_cvt_pk_bf16_f32 v97, v98, v99
    v_cvt_pk_bf16_f32 v98, v100, v101
    v_cvt_pk_bf16_f32 v99, v102, v103
    s_nop 0
    v_permlane16_swap_b32 v96, v98
    v_permlane16_swap_b32 v97, v99
    buffer_store_dwordx4 v[96:99], v1, s[32:35], s58 offen offset:0 sc1
    v_pk_mul_f32 v[112:113], v[112:113], v[40:41]
    v_pk_mul_f32 v[114:115], v[114:115], v[42:43]
    v_pk_mul_f32 v[116:117], v[116:117], v[44:45]
    v_pk_mul_f32 v[118:119], v[118:119], v[46:47]
    v_cvt_pk_bf16_f32 v112, v112, v113
    v_cvt_pk_bf16_f32 v113, v114, v115
    v_cvt_pk_bf16_f32 v114, v116, v117
    v_cvt_pk_bf16_f32 v115, v118, v119
    s_nop 0
    v_permlane16_swap_b32 v112, v114
    v_permlane16_swap_b32 v113, v115
    buffer_store_dwordx4 v[112:115], v1, s[32:35], s58 offen offset:1024 sc1
KF_C:
    s_load_dwordx2 s[12:13], s[0:1], 64
    v_mov_b32 v28, 0
    v_mov_b32 v29, 0
    v_mov_b32 v30, 0
    v_mov_b32 v31, 0
    s_waitcnt vmcnt(10)
    v_mfma_f32_32x32x16_bf16 v[32:47], v[144:147], v[128:131], 0
    v_mfma_f32_32x32x16_bf16 v[64:79], v[28:31], v[28:31], 0
    v_mfma_f32_32x32x16_bf16 v[80:95], v[28:31], v[28:31], 0
    v_mfma_f32_32x32x16_bf16 v[96:111], v[28:31], v[28:31], 0
    v_mfma_f32_32x32x16_bf16 v[112:127], v[28:31], v[28:31], 0
    s_lshr_b32 s38, s89, 1
    s_lshl_b32 s38, s38, 11
    v_and_b32 v21, 15, v0
    v_lshl_add_u32 v21, v21, 7, s38
    s_mov_b32 s96, 32768
    s_lshl_b32 s44, s89, 1
    s_add_u32 s44, s44, s62
    s_mul_i32 s38, s44, 112
    s_mul_i32 s39, s63, 28
    s_add_u32 s38, s38, s39
    s_lshl_b32 s38, s38, 10
    s_add_u32 s38, s38, 0x600000
    s_add_u32 s32, s14, s38
    s_addc_u32 s33, s15, 0
    s_mov_b32 s34, 0x7000
    s_mov_b32 s35, 0x20000
    s_lshl_b32 s38, s39, 14
    s_lshl_b32 s45, s88, 7
    s_add_u32 s38, s38, s45
    s_sub_u32 s39, 1835008, s38
    s_waitcnt lgkmcnt(0)
    s_add_u32 s48, s76, s38
    s_addc_u32 s49, s77, 0
    s_mov_b32 s50, s39
    s_mov_b32 s51, 0x20000
    s_mov_b32 s40, s78
    s_mov_b32 s41, s79
    s_mov_b32 s42, 0x80000
    s_mov_b32 s43, 0x20000
    s_lshl_b32 s60, s3, 13
    s_lshl_b32 s47, s3, 16
    s_add_u32 s47, s47, s45
    s_setprio 3
    v_exp_f32 v32, v32
    v_exp_f32 v33, v33
    v_exp_f32 v34, v34
    v_exp_f32 v35, v35
    v_exp_f32 v36, v36
    s_waitcnt vmcnt(7)
    v_mfma_f32_32x32x16_bf16 v[48:63], v[144:147], v[132:135], 0
    v_exp_f32 v37, v37
    v_exp_f32 v38, v38
    v_exp_f32 v39, v39
    v_exp_f32 v40, v40
    v_exp_f32 v41, v41
    s_waitcnt vmcnt(5)
    v_smfmac_f32_32x32x32_bf16 v[64:79], v[152:155], v[32:39], v19
    v_exp_f32 v42, v42
    v_exp_f32 v43, v43
    v_mfma_f32_32x32x16_bf16 v[184:199], v[28:31], v[28:31], 0
    v_exp_f32 v44, v44
    v_exp_f32 v45, v45
    v_exp_f32 v46, v46
    v_exp_f32 v47, v47
    s_setprio 2
    v_exp_f32 v48, v48
    v_exp_f32 v49, v49
    v_smfmac_f32_32x32x32_bf16 v[64:79], v[156:159], v[40:47], v19
    v_exp_f32 v50, v50
    v_exp_f32 v51, v51
    v_exp_f32 v52, v52
    v_mfma_f32_32x32x16_bf16 v[32:47], v[144:147], v[136:139], 0
    v_exp_f32 v53, v53
    v_exp_f32 v54, v54
    v_exp_f32 v55, v55
    v_exp_f32 v56, v56
    v_exp_f32 v57, v57
    v_smfmac_f32_32x32x32_bf16 v[80:95], v[152:155], v[48:55], v19
    v_exp_f32 v58, v58
    v_exp_f32 v59, v59
    v_mfma_f32_32x32x16_bf16 v[200:215], v[28:31], v[28:31], 0
    v_exp_f32 v60, v60
    v_exp_f32 v61, v61
    v_exp_f32 v62, v62
    v_exp_f32 v63, v63
    s_setprio 1
    v_exp_f32 v32, v32
    v_exp_f32 v33, v33
    v_smfmac_f32_32x32x32_bf16 v[80:95], v[156:159], v[56:63], v19
    v_exp_f32 v34, v34
    v_exp_f32 v35, v35
    v_exp_f32 v36, v36
    v_mfma_f32_32x32x16_bf16 v[48:63], v[144:147], v[140:143], 0
    buffer_load_dwordx4 v[144:147], v1, s[8:11], s72 offen sc1
    v_exp_f32 v37, v37
    v_exp_f32 v38, v38
    v_exp_f32 v39, v39
    v_exp_f32 v40, v40
    v_exp_f32 v41, v41
    v_smfmac_f32_32x32x32_bf16 v[96:111], v[152:155], v[32:39], v19
    v_exp_f32 v42, v42
    v_exp_f32 v43, v43
    s_lshl_b32 s38, s3, 8
    s_add_u32 s38, s38, 161792
    v_lshl_add_u32 v233, v0, 2, s38
    v_xor_b32 v234, 1024, v233
    v_mov_b32 v232, 0
    ds_write_b32 v233, v232
    v_exp_f32 v44, v44
    v_exp_f32 v45, v45
    v_exp_f32 v46, v46
    v_exp_f32 v47, v47
    s_setprio 0
    v_exp_f32 v48, v48
    v_exp_f32 v49, v49
    v_smfmac_f32_32x32x32_bf16 v[96:111], v[156:159], v[40:47], v19
    v_exp_f32 v50, v50
    v_exp_f32 v51, v51
    v_exp_f32 v52, v52
    s_waitcnt vmcnt(5)
    v_mfma_f32_32x32x16_bf16 v[32:47], v[148:151], v[128:131], 0
    v_exp_f32 v53, v53
    v_exp_f32 v54, v54
    v_exp_f32 v55, v55
    v_exp_f32 v56, v56
    v_exp_f32 v57, v57
    v_smfmac_f32_32x32x32_bf16 v[112:127], v[152:155], v[48:55], v19
    v_exp_f32 v58, v58
    v_exp_f32 v59, v59
    v_exp_f32 v60, v60
    v_exp_f32 v61, v61
    v_exp_f32 v62, v62
    v_exp_f32 v63, v63
    s_waitcnt lgkmcnt(0)
    s_barrier
    s_add_u32 s38, s59, 0
    v_mov_b32 v4, 1
    s_mov_b64 exec, 1
    buffer_store_dword v4, v22, s[80:83], s38 offen sc1
    s_mov_b64 exec, -1
    s_setprio 3
    v_exp_f32 v32, v32
    v_exp_f32 v33, v33
    v_smfmac_f32_32x32x32_bf16 v[112:127], v[156:159], v[56:63], v19
    s_mov_b64 exec, s[74:75]
    buffer_load_dwordx4 v[152:155], v18, s[64:67], s72 offen sc1
    buffer_load_dwordx4 v[156:159], v18, s[64:67], s72 offen offset:512 sc1
    s_mov_b64 exec, -1
    s_add_u32 s72, s72, 1024
    s_and_b32 s72, s72, 0x3fff
    v_exp_f32 v34, v34
    v_exp_f32 v35, v35
    v_exp_f32 v36, v36
    v_mfma_f32_32x32x16_bf16 v[48:63], v[148:151], v[132:135], 0
    v_exp_f32 v37, v37
    v_exp_f32 v38, v38
    v_exp_f32 v39, v39
    v_exp_f32 v40, v40
    v_exp_f32 v41, v41
    s_waitcnt vmcnt(6)
    v_smfmac_f32_32x32x32_bf16 v[64:79], v[160:163], v[32:39], v19
    v_exp_f32 v42, v42
    v_exp_f32 v43, v43
    s_add_u32 m0, s60, 0
    s_add_u32 s38, s47, 0
    buffer_load_dwordx4 v23, s[40:43], s38 offen lds
    s_add_u32 s38, s38, 7168
    buffer_load_dwordx4 v23, s[40:43], s38 offen offset:1024 lds
    v_exp_f32 v44, v44
    v_exp_f32 v45, v45
    v_exp_f32 v46, v46
    v_exp_f32 v47, v47
    s_setprio 2
    v_exp_f32 v48, v48
    v_exp_f32 v49, v49
    v_smfmac_f32_32x32x32_bf16 v[64:79], v[164:167], v[40:47], v19
    v_exp_f32 v50, v50
    v_exp_f32 v51, v51
    v_exp_f32 v52, v52
    v_mfma_f32_32x32x16_bf16 v[32:47], v[148:151], v[136:139], 0
    v_exp_f32 v53, v53
    v_exp_f32 v54, v54
    v_exp_f32 v55, v55
    v_exp_f32 v56, v56
    v_exp_f32 v57, v57
    v_smfmac_f32_32x32x32_bf16 v[80:95], v[160:163], v[48:55], v19
    v_exp_f32 v58, v58
    v_exp_f32 v59, v59
    s_add_u32 m0, s60, 2048
    s_add_u32 s38, s47, 16384
    buffer_load_dwordx4 v23, s[40:43], s38 offen lds
    s_add_u32 s38, s38, 7168
    buffer_load_dwordx4 v23, s[40:43], s38 offen offset:1024 lds
    v_exp_f32 v60, v60
    v_exp_f32 v61, v61
    v_exp_f32 v62, v62
    v_exp_f32 v63, v63
    s_setprio 1
    v_exp_f32 v32, v32
    v_exp_f32 v33, v33
    v_smfmac_f32_32x32x32_bf16 v[80:95], v[164:167], v[56:63], v19
    v_exp_f32 v34, v34
    v_exp_f32 v35, v35
    v_exp_f32 v36, v36
    v_mfma_f32_32x32x16_bf16 v[48:63], v[148:151], v[140:143], 0
    buffer_load_dwordx4 v[148:151], v1, s[8:11], s72 offen sc1
    v_exp_f32 v37, v37
    v_exp_f32 v38, v38
    v_exp_f32 v39, v39
    v_exp_f32 v40, v40
    v_exp_f32 v41, v41
    v_smfmac_f32_32x32x32_bf16 v[96:111], v[160:163], v[32:39], v19
    v_exp_f32 v42, v42
    v_exp_f32 v43, v43
    s_add_u32 m0, s60, 4096
    s_add_u32 s38, s47, 32768
    buffer_load_dwordx4 v23, s[40:43], s38 offen lds
    s_add_u32 s38, s38, 7168
    buffer_load_dwordx4 v23, s[40:43], s38 offen offset:1024 lds
    v_exp_f32 v44, v44
    v_exp_f32 v45, v45
    v_exp_f32 v46, v46
    v_exp_f32 v47, v47
    s_setprio 0
    v_exp_f32 v48, v48
    v_exp_f32 v49, v49
    v_smfmac_f32_32x32x32_bf16 v[96:111], v[164:167], v[40:47], v19
    v_exp_f32 v50, v50
    v_exp_f32 v51, v51
    v_exp_f32 v52, v52
    s_waitcnt vmcnt(10)
    v_mfma_f32_32x32x16_bf16 v[32:47], v[144:147], v[128:131], 0
    v_exp_f32 v53, v53
    v_exp_f32 v54, v54
    v_exp_f32 v55, v55
    v_exp_f32 v56, v56
    v_exp_f32 v57, v57
    v_smfmac_f32_32x32x32_bf16 v[112:127], v[160:163], v[48:55], v19
    v_exp_f32 v58, v58
    v_exp_f32 v59, v59
    s_add_u32 m0, s60, 6144
    s_add_u32 s38, s47, 49152
    buffer_load_dwordx4 v23, s[40:43], s38 offen lds
    s_add_u32 s38, s38, 7168
    buffer_load_dwordx4 v23, s[40:43], s38 offen offset:1024 lds
    v_exp_f32 v60, v60
    v_exp_f32 v61, v61
    v_exp_f32 v62, v62
    v_exp_f32 v63, v63
    s_setprio 3
    v_exp_f32 v32, v32
    v_exp_f32 v33, v33
    v_smfmac_f32_32x32x32_bf16 v[112:127], v[164:167], v[56:63], v19
    s_mov_b64 exec, s[74:75]
    buffer_load_dwordx4 v[160:163], v18, s[64:67], s72 offen sc1
    buffer_load_dwordx4 v[164:167], v18, s[64:67], s72 offen offset:512 sc1
    s_mov_b64 exec, -1
    s_add_u32 s72, s72, 1024
    s_and_b32 s72, s72, 0x3fff
    v_exp_f32 v34, v34
    v_exp_f32 v35, v35
    v_exp_f32 v36, v36
    v_mfma_f32_32x32x16_bf16 v[48:63], v[144:147], v[132:135], 0
    s_and_b32 s20, s98, 15
    s_lshr_b64 s[98:99], s[98:99], 4
    s_add_u32 m0, s17, 0
    s_lshl_b32 s21, s20, 15
    s_lshl_b32 s20, s20, 11
    buffer_load_dwordx4 v24, s[48:51], s21 offen offset:0 lds
    v_exp_f32 v37, v37
    v_exp_f32 v38, v38
    v_exp_f32 v39, v39
    v_exp_f32 v40, v40
    v_exp_f32 v41, v41
    s_waitcnt vmcnt(12)
    v_smfmac_f32_32x32x32_bf16 v[64:79], v[152:155], v[32:39], v19
    v_exp_f32 v42, v42
    v_exp_f32 v43, v43
    s_add_u32 s28, s63, 1
    s_and_b32 s28, s28, 3
    s_lshl_b32 s38, s62, 2
    s_add_u32 s28, s28, s38
    s_mul_i32 s28, s28, 3
    s_add_u32 s28, s28, 0
    s_mul_i32 s28, s28, 2304
    s_add_u32 s28, s28, 98304
    v_add_u32 v236, s28, v1
    v_lshl_add_u32 v237, v0, 2, s28
    v_exp_f32 v44, v44
    v_exp_f32 v45, v45
    v_exp_f32 v46, v46
    v_exp_f32 v47, v47
    s_setprio 2
    v_exp_f32 v48, v48
    v_exp_f32 v49, v49
    v_smfmac_f32_32x32x32_bf16 v[64:79], v[156:159], v[40:47], v19
    v_exp_f32 v50, v50
    v_exp_f32 v51, v51
    v_exp_f32 v52, v52
    v_mfma_f32_32x32x16_bf16 v[32:47], v[144:147], v[136:139], 0
    buffer_load_dwordx4 v25, s[48:51], s21 offen offset:2048 lds
    v_exp_f32 v53, v53
    v_exp_f32 v54, v54
    v_exp_f32 v55, v55
    v_exp_f32 v56, v56
    v_exp_f32 v57, v57
    v_smfmac_f32_32x32x32_bf16 v[80:95], v[152:155], v[48:55], v19
    v_exp_f32 v58, v58
    v_exp_f32 v59, v59
    s_add_u32 s28, s63, 2
    s_and_b32 s28, s28, 3
    s_lshl_b32 s38, s62, 2
    s_add_u32 s28, s28, s38
    s_mul_i32 s28, s28, 3
    s_add_u32 s28, s28, 1
    s_mul_i32 s28, s28, 2304
    s_add_u32 s28, s28, 98304
    v_add_u32 v238, s28, v1
    v_lshl_add_u32 v239, v0, 2, s28
    v_exp_f32 v60, v60
    v_exp_f32 v61, v61
    v_exp_f32 v62, v62
    v_exp_f32 v63, v63
    s_setprio 1
    v_exp_f32 v32, v32
    v_exp_f32 v33, v33
    v_smfmac_f32_32x32x32_bf16 v[80:95], v[156:159], v[56:63], v19
    v_exp_f32 v34, v34
    v_exp_f32 v35, v35
    v_exp_f32 v36, v36
    v_mfma_f32_32x32x16_bf16 v[48:63], v[144:147], v[140:143], 0
    buffer_load_dwordx4 v[144:147], v1, s[8:11], s72 offen sc1
    v_exp_f32 v37, v37
    v_exp_f32 v38, v38
    v_exp_f32 v39, v39
    v_exp_f32 v40, v40
    v_exp_f32 v41, v41
    v_smfmac_f32_32x32x32_bf16 v[96:111], v[152:155], v[32:39], v19
    v_exp_f32 v42, v42
    v_exp_f32 v43, v43
    buffer_load_dword v20, v21, s[80:83], 0 offen sc1
    s_add_u32 s28, s63, 3
    s_and_b32 s28, s28, 3
    s_lshl_b32 s38, s62, 2
    s_add_u32 s28, s28, s38
    s_mul_i32 s28, s28, 3
    s_add_u32 s28, s28, 2
    s_mul_i32 s28, s28, 2304
    s_add_u32 s28, s28, 98304
    v_add_u32 v240, s28, v1
    v_lshl_add_u32 v241, v0, 2, s28
    v_exp_f32 v44, v44
    v_exp_f32 v45, v45
    v_exp_f32 v46, v46
    v_exp_f32 v47, v47
    s_setprio 0
    v_exp_f32 v48, v48
    v_exp_f32 v49, v49
    v_smfmac_f32_32x32x32_bf16 v[96:111], v[156:159], v[40:47], v19
    v_exp_f32 v50, v50
    v_exp_f32 v51, v51
    v_exp_f32 v52, v52
    s_waitcnt vmcnt(10)
    v_mfma_f32_32x32x16_bf16 v[32:47], v[148:151], v[128:131], 0
    v_exp_f32 v53, v53
    v_exp_f32 v54, v54
    v_exp_f32 v55, v55
    v_exp_f32 v56, v56
    v_exp_f32 v57, v57
    v_smfmac_f32_32x32x32_bf16 v[112:127], v[152:155], v[48:55], v19
    v_exp_f32 v58, v58
    v_exp_f32 v59, v59
    s_mul_i32 s28, s3, 6912
    s_add_u32 s28, s28, 98304
    v_add_u32 v242, s28, v1
    v_lshl_add_u32 v243, v0, 2, s28
    v_exp_f32 v60, v60
    v_exp_f32 v61, v61
    v_exp_f32 v62, v62
    v_exp_f32 v63, v63
    s_mov_b32 s36, s20
    s_barrier
    s_add_u32 s38, s59, 32768
    v_mov_b32 v4, 1
    s_mov_b64 exec, 1
    buffer_store_dword v4, v22, s[80:83], s38 offen sc1
    s_mov_b64 exec, -1
    s_setprio 3
    v_exp_f32 v32, v32
    v_exp_f32 v33, v33
    v_smfmac_f32_32x32x32_bf16 v[112:127], v[156:159], v[56:63], v19
    s_mov_b64 exec, s[74:75]
    buffer_load_dwordx4 v[152:155], v18, s[64:67], s72 offen sc1
    buffer_load_dwordx4 v[156:159], v18, s[64:67], s72 offen offset:512 sc1
    s_mov_b64 exec, -1
    s_add_u32 s72, s72, 1024
    s_and_b32 s72, s72, 0x3fff
    v_exp_f32 v34, v34
    v_exp_f32 v35, v35
    v_exp_f32 v36, v36
    v_mfma_f32_32x32x16_bf16 v[48:63], v[148:151], v[132:135], 0
    s_and_b32 s20, s98, 15
    s_lshr_b64 s[98:99], s[98:99], 4
    s_add_u32 m0, s17, 16384
    s_lshl_b32 s21, s20, 15
    s_lshl_b32 s20, s20, 11
    buffer_load_dwordx4 v24, s[48:51], s21 offen offset:0 lds
    v_exp_f32 v37, v37
    v_exp_f32 v38, v38
    v_exp_f32 v39, v39
    v_exp_f32 v40, v40
    v_exp_f32 v41, v41
    s_waitcnt vmcnt(8)
    v_smfmac_f32_32x32x32_bf16 v[64:79], v[160:163], v[32:39], v19
    v_exp_f32 v42, v42
    v_exp_f32 v43, v43
    s_add_u32 s52, s14, 0xe00000
    s_addc_u32 s53, s15, 0
    s_mov_b32 s54, 0x200000
    s_mov_b32 s55, 0x20000
    v_exp_f32 v44, v44
    v_exp_f32 v45, v45
    v_exp_f32 v46, v46
    v_exp_f32 v47, v47
    s_setprio 2
    v_exp_f32 v48, v48
    v_exp_f32 v49, v49
    v_smfmac_f32_32x32x32_bf16 v[64:79], v[164:167], v[40:47], v19
    v_exp_f32 v50, v50
    v_exp_f32 v51, v51
    v_exp_f32 v52, v52
    v_mfma_f32_32x32x16_bf16 v[32:47], v[148:151], v[136:139], 0
    buffer_load_dwordx4 v25, s[48:51], s21 offen offset:2048 lds
    v_exp_f32 v53, v53
    v_exp_f32 v54, v54
    v_exp_f32 v55, v55
    v_exp_f32 v56, v56
    v_exp_f32 v57, v57
    v_smfmac_f32_32x32x32_bf16 v[80:95], v[160:163], v[48:55], v19
    v_exp_f32 v58, v58
    v_exp_f32 v59, v59
    s_waitcnt vmcnt(5)
    v_cmp_le_u32 vcc, 1, v20
    s_mov_b32 s38, 0x8000
    s_cmp_eq_u64 vcc, -1
    s_cbranch_scc1 KF_SH_OK
KF_SH:
    s_sleep 4
    buffer_load_dword v20, v21, s[80:83], 0 offen sc1
    s_sub_u32 s38, s38, 1
    s_waitcnt vmcnt(0)
    v_cmp_le_u32 vcc, 1, v20
    s_cselect_b32 s39, 1, 0
    s_cmp_eq_u64 vcc, -1
    s_cselect_b32 s39, 1, s39
    s_cmp_eq_u32 s39, 0
    s_cbranch_scc1 KF_SH
KF_SH_OK:
    buffer_load_dwordx4 v[216:219], v1, s[32:35], s36 offen offset:0 sc1
    buffer_load_dwordx4 v[220:223], v1, s[32:35], s36 offen offset:1024 sc1
    buffer_load_dwordx4 v[224:227], v1, s[32:35], s20 offen offset:0 sc1
    v_exp_f32 v60, v60
    v_exp_f32 v61, v61
    v_exp_f32 v62, v62
    v_exp_f32 v63, v63
    s_setprio 1
    v_exp_f32 v32, v32
    v_exp_f32 v33, v33
    v_smfmac_f32_32x32x32_bf16 v[80:95], v[164:167], v[56:63], v19
    v_exp_f32 v34, v34
    v_exp_f32 v35, v35
    v_exp_f32 v36, v36
    v_mfma_f32_32x32x16_bf16 v[48:63], v[148:151], v[140:143], 0
    buffer_load_dwordx4 v[148:151], v1, s[8:11], s72 offen sc1
    v_add_u32 v232, 1, v232
    ds_write_b32 v233, v232
    v_exp_f32 v37, v37
    v_exp_f32 v38, v38
    v_exp_f32 v39, v39
    v_exp_f32 v40, v40
    v_exp_f32 v41, v41
    v_smfmac_f32_32x32x32_bf16 v[96:111], v[160:163], v[32:39], v19
    v_exp_f32 v42, v42
    v_exp_f32 v43, v43
    s_add_u32 s24, s14, 0x1000000
    s_addc_u32 s25, s15, 0
    s_mov_b32 s26, 0x4000
    s_mov_b32 s27, 0x20000
    s_lshl_b32 s39, s44, 8
    v_and_b32 v4, 31, v0
    v_lshlrev_b32 v4, 3, v4
    buffer_load_dword v245, v4, s[24:27], s39 offen offset:4 sc1
    s_lshl_b32 s39, s88, 3
    s_add_u32 s39, s39, s3
    s_lshl_b32 s39, s39, 8
    buffer_load_dword v246, v4, s[24:27], s39 offen sc1
    v_exp_f32 v44, v44
    v_exp_f32 v45, v45
    v_exp_f32 v46, v46
    v_exp_f32 v47, v47
    s_setprio 0
    v_exp_f32 v48, v48
    v_exp_f32 v49, v49
    v_smfmac_f32_32x32x32_bf16 v[96:111], v[164:167], v[40:47], v19
    v_exp_f32 v50, v50
    v_exp_f32 v51, v51
    v_exp_f32 v52, v52
    v_mfma_f32_32x32x16_bf16 v[32:47], v[144:147], v[128:131], 0
    ds_read_b32 v235, v234
    v_exp_f32 v53, v53
    v_exp_f32 v54, v54
    v_exp_f32 v55, v55
    v_exp_f32 v56, v56
    v_exp_f32 v57, v57
    v_smfmac_f32_32x32x32_bf16 v[112:127], v[160:163], v[48:55], v19
    v_exp_f32 v58, v58
    v_exp_f32 v59, v59
    buffer_load_dwordx4 v[228:231], v1, s[32:35], s20 offen offset:1024 sc1
    s_xor_b32 s17, s17, 0x8000
    v_exp_f32 v60, v60
    v_exp_f32 v61, v61
    s_waitcnt lgkmcnt(0)
    v_cmp_lt_u32 vcc, v235, v232
    v_exp_f32 v62, v62
    v_exp_f32 v63, v63
    s_mov_b32 s46, 5
    s_mov_b32 s37, 4
.p2align 6
KF_LB:
    s_cmp_eq_u32 s46, s37
    s_cbranch_scc1 KF_EV
KF_EVR:
    s_setprio 3
    s_cbranch_vccnz KF_P0
KF_P0_OK:
    ds_read_b64_tr_b16 v[168:169], v26 offset:0
    ds_read_b64_tr_b16 v[170:171], v26 offset:512
    ds_read_b64_tr_b16 v[172:173], v27 offset:0
    ds_read_b64_tr_b16 v[174:175], v27 offset:512
    v_exp_f32 v32, v32
    v_exp_f32 v33, v33
    v_smfmac_f32_32x32x32_bf16 v[112:127], v[164:167], v[56:63], v19
    s_mov_b64 exec, s[74:75]
    buffer_load_dwordx4 v[160:163], v18, s[64:67], s72 offen sc1
    buffer_load_dwordx4 v[164:167], v18, s[64:67], s72 offen offset:512 sc1
    s_mov_b64 exec, -1
    s_add_u32 s72, s72, 1024
    s_and_b32 s72, s72, 0x3fff
    v_exp_f32 v34, v34
    v_exp_f32 v35, v35
    v_exp_f32 v36, v36
    v_mfma_f32_32x32x16_bf16 v[48:63], v[144:147], v[132:135], 0
    s_and_b32 s20, s98, 15
    s_lshr_b64 s[98:99], s[98:99], 4
    s_add_u32 m0, s17, 0
    s_lshl_b32 s21, s20, 15
    s_lshl_b32 s20, s20, 11
    buffer_load_dwordx4 v24, s[48:51], s21 offen offset:0 lds
    v_exp_f32 v37, v37
    v_exp_f32 v38, v38
    v_exp_f32 v39, v39
    v_exp_f32 v40, v40
    v_exp_f32 v41, v41
    s_waitcnt vmcnt(8)
    v_smfmac_f32_32x32x32_bf16 v[64:79], v[152:155], v[32:39], v19
    v_exp_f32 v42, v42
    v_exp_f32 v43, v43
    s_waitcnt lgkmcnt(2)
    s_waitcnt vmcnt(9)
    v_mfma_f32_32x32x16_bf16 v[184:199], v[168:171], v[216:219], v[184:199]
    v_exp_f32 v44, v44
    v_exp_f32 v45, v45
    v_exp_f32 v46, v46
    v_exp_f32 v47, v47
    s_setprio 2
    v_exp_f32 v48, v48
    v_exp_f32 v49, v49
    v_smfmac_f32_32x32x32_bf16 v[64:79], v[156:159], v[40:47], v19
    ds_read_b64_tr_b16 v[176:177], v26 offset:2048
    ds_read_b64_tr_b16 v[178:179], v26 offset:2560
    ds_read_b64_tr_b16 v[180:181], v27 offset:2048
    ds_read_b64_tr_b16 v[182:183], v27 offset:2560
    v_exp_f32 v50, v50
    v_exp_f32 v51, v51
    v_exp_f32 v52, v52
    v_mfma_f32_32x32x16_bf16 v[32:47], v[144:147], v[136:139], 0
    buffer_load_dwordx4 v25, s[48:51], s21 offen offset:2048 lds
    v_exp_f32 v53, v53
    v_exp_f32 v54, v54
    v_exp_f32 v55, v55
    v_exp_f32 v56, v56
    v_exp_f32 v57, v57
    v_smfmac_f32_32x32x32_bf16 v[80:95], v[152:155], v[48:55], v19
    v_exp_f32 v58, v58
    v_exp_f32 v59, v59
    s_waitcnt lgkmcnt(4)
    v_mfma_f32_32x32x16_bf16 v[200:215], v[172:175], v[216:219], v[200:215]
    buffer_load_dwordx4 v[216:219], v1, s[32:35], s20 offen offset:0 sc1
    v_exp_f32 v60, v60
    v_exp_f32 v61, v61
    v_exp_f32 v62, v62
    v_exp_f32 v63, v63
    s_setprio 1
    v_exp_f32 v32, v32
    v_exp_f32 v33, v33
    v_smfmac_f32_32x32x32_bf16 v[80:95], v[156:159], v[56:63], v19
    v_exp_f32 v34, v34
    v_exp_f32 v35, v35
    v_exp_f32 v36, v36
    v_mfma_f32_32x32x16_bf16 v[48:63], v[144:147], v[140:143], 0
    buffer_load_dwordx4 v[144:147], v1, s[8:11], s72 offen sc1
    v_add_u32 v232, 1, v232
    s_waitcnt vmcnt(9)
    ds_write_b32 v233, v232
    v_exp_f32 v37, v37
    v_exp_f32 v38, v38
    v_exp_f32 v39, v39
    v_exp_f32 v40, v40
    v_exp_f32 v41, v41
    v_smfmac_f32_32x32x32_bf16 v[96:111], v[152:155], v[32:39], v19
    v_exp_f32 v42, v42
    v_exp_f32 v43, v43
    s_waitcnt lgkmcnt(3)
    s_waitcnt vmcnt(11)
    v_mfma_f32_32x32x16_bf16 v[184:199], v[176:179], v[220:223], v[184:199]
    v_exp_f32 v44, v44
    v_exp_f32 v45, v45
    v_exp_f32 v46, v46
    v_exp_f32 v47, v47
    s_setprio 0
    v_exp_f32 v48, v48
    v_exp_f32 v49, v49
    v_smfmac_f32_32x32x32_bf16 v[96:111], v[156:159], v[40:47], v19
    v_exp_f32 v50, v50
    v_exp_f32 v51, v51
    v_exp_f32 v52, v52
    s_waitcnt vmcnt(7)
    v_mfma_f32_32x32x16_bf16 v[32:47], v[148:151], v[128:131], 0
    ds_read_b32 v235, v234
    v_exp_f32 v53, v53
    v_exp_f32 v54, v54
    v_exp_f32 v55, v55
    v_exp_f32 v56, v56
    v_exp_f32 v57, v57
    v_smfmac_f32_32x32x32_bf16 v[112:127], v[152:155], v[48:55], v19
    v_exp_f32 v58, v58
    v_exp_f32 v59, v59
    s_waitcnt lgkmcnt(2)
    v_mfma_f32_32x32x16_bf16 v[200:215], v[180:183], v[220:223], v[200:215]
    buffer_load_dwordx4 v[220:223], v1, s[32:35], s20 offen offset:1024 sc1
    v_exp_f32 v60, v60
    v_exp_f32 v61, v61
    s_waitcnt lgkmcnt(0)
    v_cmp_lt_u32 vcc, v235, v232
    v_exp_f32 v62, v62
    v_exp_f32 v63, v63
    s_setprio 3
    s_cbranch_vccnz KF_P1
KF_P1_OK:
    ds_read_b64_tr_b16 v[168:169], v26 offset:16384
    ds_read_b64_tr_b16 v[170:171], v26 offset:16896
    ds_read_b64_tr_b16 v[172:173], v27 offset:16384
    ds_read_b64_tr_b16 v[174:175], v27 offset:16896
    v_exp_f32 v32, v32
    v_exp_f32 v33, v33
    v_smfmac_f32_32x32x32_bf16 v[112:127], v[156:159], v[56:63], v19
    s_mov_b64 exec, s[74:75]
    buffer_load_dwordx4 v[152:155], v18, s[64:67], s72 offen sc1
    buffer_load_dwordx4 v[156:159], v18, s[64:67], s72 offen offset:512 sc1
    s_mov_b64 exec, -1
    s_add_u32 s72, s72, 1024
    s_and_b32 s72, s72, 0x3fff
    v_exp_f32 v34, v34
    v_exp_f32 v35, v35
    v_exp_f32 v36, v36
    v_mfma_f32_32x32x16_bf16 v[48:63], v[148:151], v[132:135], 0
    s_and_b32 s20, s98, 15
    s_lshr_b64 s[98:99], s[98:99], 4
    s_add_u32 m0, s17, 16384
    s_lshl_b32 s21, s20, 15
    s_lshl_b32 s20, s20, 11
    buffer_load_dwordx4 v24, s[48:51], s21 offen offset:0 lds
    v_exp_f32 v37, v37
    v_exp_f32 v38, v38
    v_exp_f32 v39, v39
    v_exp_f32 v40, v40
    v_exp_f32 v41, v41
    s_waitcnt vmcnt(8)
    v_smfmac_f32_32x32x32_bf16 v[64:79], v[160:163], v[32:39], v19
    v_exp_f32 v42, v42
    v_exp_f32 v43, v43
    s_waitcnt lgkmcnt(2)
    v_mfma_f32_32x32x16_bf16 v[184:199], v[168:171], v[224:227], v[184:199]
    v_exp_f32 v44, v44
    v_exp_f32 v45, v45
    v_exp_f32 v46, v46
    v_exp_f32 v47, v47
    s_setprio 2
    v_exp_f32 v48, v48
    v_exp_f32 v49, v49
    v_smfmac_f32_32x32x32_bf16 v[64:79], v[164:167], v[40:47], v19
    ds_read_b64_tr_b16 v[176:177], v26 offset:18432
    ds_read_b64_tr_b16 v[178:179], v26 offset:18944
    ds_read_b64_tr_b16 v[180:181], v27 offset:18432
    ds_read_b64_tr_b16 v[182:183], v27 offset:18944
    v_exp_f32 v50, v50
    v_exp_f32 v51, v51
    v_exp_f32 v52, v52
    v_mfma_f32_32x32x16_bf16 v[32:47], v[148:151], v[136:139], 0
    buffer_load_dwordx4 v25, s[48:51], s21 offen offset:2048 lds
    v_exp_f32 v53, v53
    v_exp_f32 v54, v54
    v_exp_f32 v55, v55
    v_exp_f32 v56, v56
    v_exp_f32 v57, v57
    v_smfmac_f32_32x32x32_bf16 v[80:95], v[160:163], v[48:55], v19
    v_exp_f32 v58, v58
    v_exp_f32 v59, v59
    s_waitcnt lgkmcnt(4)
    v_mfma_f32_32x32x16_bf16 v[200:215], v[172:175], v[224:227], v[200:215]
    buffer_load_dwordx4 v[224:227], v1, s[32:35], s20 offen offset:0 sc1
    v_exp_f32 v60, v60
    v_exp_f32 v61, v61
    v_exp_f32 v62, v62
    v_exp_f32 v63, v63
    s_setprio 1
    v_exp_f32 v32, v32
    v_exp_f32 v33, v33
    v_smfmac_f32_32x32x32_bf16 v[80:95], v[164:167], v[56:63], v19
    v_exp_f32 v34, v34
    v_exp_f32 v35, v35
    v_exp_f32 v36, v36
    v_mfma_f32_32x32x16_bf16 v[48:63], v[148:151], v[140:143], 0
    buffer_load_dwordx4 v[148:151], v1, s[8:11], s72 offen sc1
    v_add_u32 v232, 1, v232
    s_waitcnt vmcnt(9)
    ds_write_b32 v233, v232
    v_exp_f32 v37, v37
    v_exp_f32 v38, v38
    v_exp_f32 v39, v39
    v_exp_f32 v40, v40
    v_exp_f32 v41, v41
    v_smfmac_f32_32x32x32_bf16 v[96:111], v[160:163], v[32:39], v19
    v_exp_f32 v42, v42
    v_exp_f32 v43, v43
    s_waitcnt lgkmcnt(3)
    v_mfma_f32_32x32x16_bf16 v[184:199], v[176:179], v[228:231], v[184:199]
    v_exp_f32 v44, v44
    v_exp_f32 v45, v45
    v_exp_f32 v46, v46
    v_exp_f32 v47, v47
    s_setprio 0
    v_exp_f32 v48, v48
    v_exp_f32 v49, v49
    v_smfmac_f32_32x32x32_bf16 v[96:111], v[164:167], v[40:47], v19
    v_exp_f32 v50, v50
    v_exp_f32 v51, v51
    v_exp_f32 v52, v52
    s_waitcnt vmcnt(7)
    v_mfma_f32_32x32x16_bf16 v[32:47], v[144:147], v[128:131], 0
    ds_read_b32 v235, v234
    v_exp_f32 v53, v53
    v_exp_f32 v54, v54
    v_exp_f32 v55, v55
    v_exp_f32 v56, v56
    v_exp_f32 v57, v57
    v_smfmac_f32_32x32x32_bf16 v[112:127], v[160:163], v[48:55], v19
    v_exp_f32 v58, v58
    v_exp_f32 v59, v59
    s_waitcnt lgkmcnt(2)
    v_mfma_f32_32x32x16_bf16 v[200:215], v[180:183], v[228:231], v[200:215]
    buffer_load_dwordx4 v[228:231], v1, s[32:35], s20 offen offset:1024 sc1
    v_xor_b32 v26, 0x8000, v26
    v_xor_b32 v27, 0x8000, v27
    s_xor_b32 s17, s17, 0x8000
    s_sub_u32 s46, s46, 1
    s_cmp_lg_u32 s46, 0
    v_exp_f32 v60, v60
    v_exp_f32 v61, v61
    s_waitcnt lgkmcnt(0)
    v_cmp_lt_u32 vcc, v235, v232
    v_exp_f32 v62, v62
    v_exp_f32 v63, v63
    s_cbranch_scc1 KF_LB
    s_lshl_b32 s60, s44, 15
    s_lshl_b32 s39, s63, 13
    s_add_u32 s60, s60, s39
    s_add_u32 s47, s60, 4096
    s_setprio 3
    s_cbranch_vccnz KF_P2
KF_P2_OK:
    ds_read_b64_tr_b16 v[168:169], v26 offset:0
    ds_read_b64_tr_b16 v[170:171], v26 offset:512
    ds_read_b64_tr_b16 v[172:173], v27 offset:0
    ds_read_b64_tr_b16 v[174:175], v27 offset:512
    v_exp_f32 v32, v32
    v_exp_f32 v33, v33
    v_smfmac_f32_32x32x32_bf16 v[112:127], v[164:167], v[56:63], v19
    s_mov_b64 exec, s[74:75]
    buffer_load_dwordx4 v[160:163], v18, s[64:67], s72 offen sc1
    buffer_load_dwordx4 v[164:167], v18, s[64:67], s72 offen offset:512 sc1
    s_mov_b64 exec, -1
    s_add_u32 s72, s72, 1024
    s_and_b32 s72, s72, 0x3fff
    v_exp_f32 v34, v34
    v_exp_f32 v35, v35
    v_exp_f32 v36, v36
    v_mfma_f32_32x32x16_bf16 v[48:63], v[144:147], v[132:135], 0
    s_and_b32 s20, s98, 15
    s_lshr_b64 s[98:99], s[98:99], 4
    s_add_u32 m0, s17, 0
    s_lshl_b32 s21, s20, 15
    s_lshl_b32 s20, s20, 11
    buffer_load_dwordx4 v24, s[48:51], s21 offen offset:0 lds
    v_exp_f32 v37, v37
    v_exp_f32 v38, v38
    v_exp_f32 v39, v39
    v_exp_f32 v40, v40
    v_exp_f32 v41, v41
    s_waitcnt vmcnt(8)
    v_smfmac_f32_32x32x32_bf16 v[64:79], v[152:155], v[32:39], v19
    v_exp_f32 v42, v42
    v_exp_f32 v43, v43
    s_waitcnt lgkmcnt(2)
    v_mfma_f32_32x32x16_bf16 v[184:199], v[168:171], v[216:219], v[184:199]
    v_exp_f32 v44, v44
    v_exp_f32 v45, v45
    v_exp_f32 v46, v46
    v_exp_f32 v47, v47
    s_setprio 2
    v_exp_f32 v48, v48
    v_exp_f32 v49, v49
    v_smfmac_f32_32x32x32_bf16 v[64:79], v[156:159], v[40:47], v19
    ds_read_b64_tr_b16 v[176:177], v26 offset:2048
    ds_read_b64_tr_b16 v[178:179], v26 offset:2560
    ds_read_b64_tr_b16 v[180:181], v27 offset:2048
    ds_read_b64_tr_b16 v[182:183], v27 offset:2560
    v_exp_f32 v50, v50
    v_exp_f32 v51, v51
    v_exp_f32 v52, v52
    v_mfma_f32_32x32x16_bf16 v[32:47], v[144:147], v[136:139], 0
    buffer_load_dwordx4 v25, s[48:51], s21 offen offset:2048 lds
    v_exp_f32 v53, v53
    v_exp_f32 v54, v54
    v_exp_f32 v55, v55
    v_exp_f32 v56, v56
    v_exp_f32 v57, v57
    v_smfmac_f32_32x32x32_bf16 v[80:95], v[152:155], v[48:55], v19
    v_exp_f32 v58, v58
    v_exp_f32 v59, v59
    s_waitcnt lgkmcnt(4)
    v_mfma_f32_32x32x16_bf16 v[200:215], v[172:175], v[216:219], v[200:215]
    buffer_load_dwordx4 v[216:219], v1, s[32:35], s20 offen offset:0 sc1
    v_exp_f32 v60, v60
    v_exp_f32 v61, v61
    v_exp_f32 v62, v62
    v_exp_f32 v63, v63
    s_setprio 1
    v_exp_f32 v32, v32
    v_exp_f32 v33, v33
    v_smfmac_f32_32x32x32_bf16 v[80:95], v[156:159], v[56:63], v19
    v_exp_f32 v34, v34
    v_exp_f32 v35, v35
    v_exp_f32 v36, v36
    v_mfma_f32_32x32x16_bf16 v[48:63], v[144:147], v[140:143], 0
    v_add_u32 v232, 1, v232
    s_waitcnt vmcnt(8)
    ds_write_b32 v233, v232
    v_exp_f32 v37, v37
    v_exp_f32 v38, v38
    v_exp_f32 v39, v39
    v_exp_f32 v40, v40
    v_exp_f32 v41, v41
    v_smfmac_f32_32x32x32_bf16 v[96:111], v[152:155], v[32:39], v19
    v_exp_f32 v42, v42
    v_exp_f32 v43, v43
    s_waitcnt lgkmcnt(3)
    v_mfma_f32_32x32x16_bf16 v[184:199], v[176:179], v[220:223], v[184:199]
    v_exp_f32 v44, v44
    v_exp_f32 v45, v45
    v_exp_f32 v46, v46
    v_exp_f32 v47, v47
    s_setprio 0
    v_exp_f32 v48, v48
    v_exp_f32 v49, v49
    v_smfmac_f32_32x32x32_bf16 v[96:111], v[156:159], v[40:47], v19
    v_exp_f32 v50, v50
    v_exp_f32 v51, v51
    v_exp_f32 v52, v52
    s_waitcnt vmcnt(6)
    v_mfma_f32_32x32x16_bf16 v[32:47], v[148:151], v[128:131], 0
    ds_read_b32 v235, v234
    v_exp_f32 v53, v53
    v_exp_f32 v54, v54
    v_exp_f32 v55, v55
    v_exp_f32 v56, v56
    v_exp_f32 v57, v57
    v_smfmac_f32_32x32x32_bf16 v[112:127], v[152:155], v[48:55], v19
    v_exp_f32 v58, v58
    v_exp_f32 v59, v59
    s_waitcnt lgkmcnt(2)
    v_mfma_f32_32x32x16_bf16 v[200:215], v[180:183], v[220:223], v[200:215]
    buffer_load_dwordx4 v[220:223], v1, s[32:35], s20 offen offset:1024 sc1
    v_exp_f32 v60, v60
    v_exp_f32 v61, v61
    s_waitcnt lgkmcnt(0)
    v_cmp_lt_u32 vcc, v235, v232
    v_exp_f32 v62, v62
    v_exp_f32 v63, v63
    s_setprio 3
    s_cbranch_vccnz KF_P3
KF_P3_OK:
    ds_read_b64_tr_b16 v[168:169], v26 offset:16384
    ds_read_b64_tr_b16 v[170:171], v26 offset:16896
    ds_read_b64_tr_b16 v[172:173], v27 offset:16384
    ds_read_b64_tr_b16 v[174:175], v27 offset:16896
    v_exp_f32 v32, v32
    v_exp_f32 v33, v33
    v_smfmac_f32_32x32x32_bf16 v[112:127], v[156:159], v[56:63], v19
    v_exp_f32 v34, v34
    v_exp_f32 v35, v35
    v_exp_f32 v36, v36
    v_mfma_f32_32x32x16_bf16 v[48:63], v[148:151], v[132:135], 0
    s_and_b32 s20, s98, 15
    s_lshr_b64 s[98:99], s[98:99], 4
    s_add_u32 m0, s17, 16384
    s_lshl_b32 s21, s20, 15
    s_lshl_b32 s20, s20, 11
    buffer_load_dwordx4 v24, s[48:51], s21 offen offset:0 lds
    v_exp_f32 v37, v37
    v_exp_f32 v38, v38
    v_exp_f32 v39, v39
    v_exp_f32 v40, v40
    v_exp_f32 v41, v41
    s_waitcnt vmcnt(5)
    v_smfmac_f32_32x32x32_bf16 v[64:79], v[160:163], v[32:39], v19
    v_exp_f32 v42, v42
    v_exp_f32 v43, v43
    s_waitcnt lgkmcnt(2)
    v_mfma_f32_32x32x16_bf16 v[184:199], v[168:171], v[224:227], v[184:199]
    v_exp_f32 v44, v44
    v_exp_f32 v45, v45
    v_exp_f32 v46, v46
    v_exp_f32 v47, v47
    s_setprio 2
    v_exp_f32 v48, v48
    v_exp_f32 v49, v49
    v_smfmac_f32_32x32x32_bf16 v[64:79], v[164:167], v[40:47], v19
    ds_read_b64_tr_b16 v[176:177], v26 offset:18432
    ds_read_b64_tr_b16 v[178:179], v26 offset:18944
    ds_read_b64_tr_b16 v[180:181], v27 offset:18432
    ds_read_b64_tr_b16 v[182:183], v27 offset:18944
    v_exp_f32 v50, v50
    v_exp_f32 v51, v51
    v_exp_f32 v52, v52
    v_mfma_f32_32x32x16_bf16 v[32:47], v[148:151], v[136:139], 0
    buffer_load_dwordx4 v25, s[48:51], s21 offen offset:2048 lds
    v_exp_f32 v53, v53
    v_exp_f32 v54, v54
    v_exp_f32 v55, v55
    v_exp_f32 v56, v56
    v_exp_f32 v57, v57
    v_smfmac_f32_32x32x32_bf16 v[80:95], v[160:163], v[48:55], v19
    v_exp_f32 v58, v58
    v_exp_f32 v59, v59
    s_waitcnt lgkmcnt(4)
    v_mfma_f32_32x32x16_bf16 v[200:215], v[172:175], v[224:227], v[200:215]
    buffer_load_dwordx4 v[224:227], v1, s[32:35], s20 offen offset:0 sc1
    v_exp_f32 v60, v60
    v_exp_f32 v61, v61
    v_exp_f32 v62, v62
    v_exp_f32 v63, v63
    s_setprio 1
    v_exp_f32 v32, v32
    v_exp_f32 v33, v33
    v_smfmac_f32_32x32x32_bf16 v[80:95], v[164:167], v[56:63], v19
    v_exp_f32 v34, v34
    v_exp_f32 v35, v35
    v_exp_f32 v36, v36
    v_mfma_f32_32x32x16_bf16 v[48:63], v[148:151], v[140:143], 0
    s_waitcnt lgkmcnt(0)
    s_barrier
    ds_write_b128 v236, v[64:67]
    ds_write_b128 v236, v[68:71] offset:1024
    ds_write_b32 v237, v72 offset:2048
    v_exp_f32 v37, v37
    v_exp_f32 v38, v38
    v_exp_f32 v39, v39
    v_exp_f32 v40, v40
    v_exp_f32 v41, v41
    v_smfmac_f32_32x32x32_bf16 v[96:111], v[160:163], v[32:39], v19
    v_exp_f32 v42, v42
    v_exp_f32 v43, v43
    v_mfma_f32_32x32x16_bf16 v[184:199], v[176:179], v[228:231], v[184:199]
    v_exp_f32 v44, v44
    v_exp_f32 v45, v45
    v_exp_f32 v46, v46
    v_exp_f32 v47, v47
    s_setprio 0
    v_exp_f32 v48, v48
    v_exp_f32 v49, v49
    v_smfmac_f32_32x32x32_bf16 v[96:111], v[164:167], v[40:47], v19
    v_exp_f32 v50, v50
    v_exp_f32 v51, v51
    v_exp_f32 v52, v52
    v_exp_f32 v53, v53
    v_exp_f32 v54, v54
    v_exp_f32 v55, v55
    v_exp_f32 v56, v56
    v_exp_f32 v57, v57
    ds_write_b128 v238, v[80:83]
    ds_write_b128 v238, v[84:87] offset:1024
    ds_write_b32 v239, v88 offset:2048
    v_smfmac_f32_32x32x32_bf16 v[112:127], v[160:163], v[48:55], v19
    v_exp_f32 v58, v58
    v_exp_f32 v59, v59
    v_mfma_f32_32x32x16_bf16 v[200:215], v[180:183], v[228:231], v[200:215]
    buffer_load_dwordx4 v[228:231], v1, s[32:35], s20 offen offset:1024 sc1
    v_xor_b32 v26, 0x8000, v26
    v_xor_b32 v27, 0x8000, v27
    s_xor_b32 s17, s17, 0x8000
    v_exp_f32 v60, v60
    v_exp_f32 v61, v61
    v_exp_f32 v62, v62
    v_exp_f32 v63, v63
    ds_write_b128 v240, v[96:99]
    ds_write_b128 v240, v[100:103] offset:1024
    ds_write_b32 v241, v104 offset:2048
    v_smfmac_f32_32x32x32_bf16 v[112:127], v[164:167], v[56:63], v19
    s_setprio 3
    s_waitcnt vmcnt(2)
    s_waitcnt lgkmcnt(0)
    s_barrier
    ds_read_b128 v[64:67], v242 offset:0
    ds_read_b128 v[68:71], v242 offset:1024
    ds_read_b32 v72, v243 offset:2048
    ds_read_b128 v[80:83], v242 offset:2304
    ds_read_b128 v[84:87], v242 offset:3328
    ds_read_b32 v88, v243 offset:4352
    ds_read_b128 v[96:99], v242 offset:4608
    ds_read_b128 v[100:103], v242 offset:5632
    ds_read_b32 v104, v243 offset:6656
    s_mov_b32 s38, 0x21800000
    v_mov_b32 v5, 0x53800000
    s_waitcnt lgkmcnt(6)
    v_add_f32 v120, v120, v72
    v_add_f32 v112, v112, v64
    v_add_f32 v113, v113, v65
    v_add_f32 v114, v114, v66
    v_add_f32 v115, v115, v67
    v_add_f32 v116, v116, v68
    v_add_f32 v117, v117, v69
    v_add_f32 v118, v118, v70
    v_add_f32 v119, v119, v71
    s_waitcnt lgkmcnt(3)
    v_add_f32 v120, v120, v88
    v_add_f32 v112, v112, v80
    v_add_f32 v113, v113, v81
    v_add_f32 v114, v114, v82
    v_add_f32 v115, v115, v83
    v_add_f32 v116, v116, v84
    v_add_f32 v117, v117, v85
    v_add_f32 v118, v118, v86
    v_add_f32 v119, v119, v87
    s_waitcnt lgkmcnt(0)
    v_add_f32 v120, v120, v104
    v_add_f32 v112, v112, v96
    v_add_f32 v113, v113, v97
    v_add_f32 v114, v114, v98
    v_add_f32 v115, v115, v99
    v_add_f32 v116, v116, v100
    v_add_f32 v117, v117, v101
    v_add_f32 v118, v118, v102
    v_add_f32 v119, v119, v103
KF_CHK:
    v_mov_b32 v4, v120
    v_pk_add_f32 v[6:7], v[112:113], v[114:115]
    v_pk_add_f32 v[8:9], v[116:117], v[118:119]
    v_permlane32_swap_b32 v120, v4
    v_pk_add_f32 v[6:7], v[6:7], v[8:9]
    s_cmp_eq_u32 s46, 1
    v_rcp_f32 v4, v120
    s_cbranch_scc1 KF_NORM
    v_add_f32 v6, v6, v7
    v_med3_f32 v5, v120, s38, v5
    v_fmac_f32 v5, 0, v6
    v_cmp_eq_f32 vcc, v5, v120
    s_nop 1
    s_cmp_eq_u64 vcc, -1
    s_cbranch_scc0 KF_SLOW
KF_NORM:
    v_mul_f32 v4, v4, v246
    v_mul_f32 v112, v112, v4
    v_mul_f32 v113, v113, v4
    v_mul_f32 v114, v114, v4
    v_mul_f32 v115, v115, v4
    v_mul_f32 v116, v116, v4
    v_mul_f32 v117, v117, v4
    v_mul_f32 v118, v118, v4
    v_mul_f32 v119, v119, v4
    v_cvt_pk_bf16_f32 v32, v112, v113
    v_cvt_pk_bf16_f32 v33, v114, v115
    v_cvt_pk_bf16_f32 v34, v116, v117
    v_cvt_pk_bf16_f32 v35, v118, v119
    v_min_u32 v32, -2, v32
    v_min_u32 v33, -2, v33
    v_min_u32 v34, -2, v34
    v_min_u32 v35, -2, v35
    buffer_store_dwordx4 v[32:35], v1, s[52:55], s61 offen sc1
    ds_read_b64_tr_b16 v[168:169], v26 offset:0
    ds_read_b64_tr_b16 v[170:171], v26 offset:512
    ds_read_b64_tr_b16 v[172:173], v27 offset:0
    ds_read_b64_tr_b16 v[174:175], v27 offset:512
    ds_read_b64_tr_b16 v[176:177], v26 offset:2048
    ds_read_b64_tr_b16 v[178:179], v26 offset:2560
    ds_read_b64_tr_b16 v[180:181], v27 offset:2048
    ds_read_b64_tr_b16 v[182:183], v27 offset:2560
    v_and_b32 v4, 31, v0
    v_and_b32 v7, 0xfff, v26
    s_lshl_b32 s39, s63, 14
    v_add_u32 v7, s39, v7
    v_lshrrev_b32 v8, 5, v0
    v_lshlrev_b32 v8, 9, v8
    v_sub_u32 v7, v7, v8
    v_xor_b32 v8, 64, v7
    s_waitcnt lgkmcnt(6)
    v_mfma_f32_32x32x16_bf16 v[184:199], v[168:171], v[216:219], v[184:199]
    s_waitcnt lgkmcnt(4)
    v_mfma_f32_32x32x16_bf16 v[200:215], v[172:175], v[216:219], v[200:215]
    ds_read_b64_tr_b16 v[168:169], v26 offset:16384
    ds_read_b64_tr_b16 v[170:171], v26 offset:16896
    ds_read_b64_tr_b16 v[172:173], v27 offset:16384
    ds_read_b64_tr_b16 v[174:175], v27 offset:16896
    s_waitcnt lgkmcnt(6)
    v_mfma_f32_32x32x16_bf16 v[184:199], v[176:179], v[220:223], v[184:199]
    s_waitcnt lgkmcnt(4)
    v_mfma_f32_32x32x16_bf16 v[200:215], v[180:183], v[220:223], v[200:215]
    ds_read_b64_tr_b16 v[176:177], v26 offset:18432
    ds_read_b64_tr_b16 v[178:179], v26 offset:18944
    ds_read_b64_tr_b16 v[180:181], v27 offset:18432
    ds_read_b64_tr_b16 v[182:183], v27 offset:18944
    ds_read_b64_tr_b16 v[64:65], v7 offset:0
    ds_read_b64_tr_b16 v[66:67], v7 offset:1024
    ds_read_b64_tr_b16 v[68:69], v8 offset:0
    ds_read_b64_tr_b16 v[70:71], v8 offset:1024
    s_waitcnt lgkmcnt(10)
    s_waitcnt vmcnt(2)
    v_mfma_f32_32x32x16_bf16 v[184:199], v[168:171], v[224:227], v[184:199]
    s_waitcnt lgkmcnt(8)
    v_mfma_f32_32x32x16_bf16 v[200:215], v[172:175], v[224:227], v[200:215]
    ds_read_b64_tr_b16 v[72:73], v7 offset:2048
    ds_read_b64_tr_b16 v[74:75], v7 offset:3072
    ds_read_b64_tr_b16 v[76:77], v8 offset:2048
    ds_read_b64_tr_b16 v[78:79], v8 offset:3072
    ds_read_b64_tr_b16 v[80:81], v7 offset:4096
    ds_read_b64_tr_b16 v[82:83], v7 offset:5120
    ds_read_b64_tr_b16 v[84:85], v8 offset:4096
    ds_read_b64_tr_b16 v[86:87], v8 offset:5120
    s_waitcnt lgkmcnt(14)
    s_waitcnt vmcnt(1)
    v_mfma_f32_32x32x16_bf16 v[184:199], v[176:179], v[228:231], v[184:199]
    s_waitcnt lgkmcnt(12)
    v_mfma_f32_32x32x16_bf16 v[200:215], v[180:183], v[228:231], v[200:215]
    buffer_load_dwordx4 v[128:131], v1, s[52:55], s60 offen offset:0 sc1
    buffer_load_dwordx4 v[132:135], v1, s[52:55], s60 offen offset:1024 sc1
    buffer_load_dwordx4 v[136:139], v1, s[52:55], s60 offen offset:2048 sc1
    buffer_load_dwordx4 v[140:143], v1, s[52:55], s60 offen offset:3072 sc1
    buffer_load_dwordx4 v[144:147], v1, s[52:55], s47 offen offset:0 sc1
    buffer_load_dwordx4 v[148:151], v1, s[52:55], s47 offen offset:1024 sc1
    buffer_load_dwordx4 v[152:155], v1, s[52:55], s47 offen offset:2048 sc1
    buffer_load_dwordx4 v[156:159], v1, s[52:55], s47 offen offset:3072 sc1
    s_waitcnt lgkmcnt(8)
    ds_read_b64_tr_b16 v[88:89], v7 offset:6144
    ds_read_b64_tr_b16 v[90:91], v7 offset:7168
    ds_read_b64_tr_b16 v[92:93], v8 offset:6144
    ds_read_b64_tr_b16 v[94:95], v8 offset:7168
    s_waitcnt lgkmcnt(8)
    ds_read_b64_tr_b16 v[96:97], v7 offset:8192
    ds_read_b64_tr_b16 v[98:99], v7 offset:9216
    ds_read_b64_tr_b16 v[100:101], v8 offset:8192
    ds_read_b64_tr_b16 v[102:103], v8 offset:9216
    s_waitcnt lgkmcnt(8)
    ds_read_b64_tr_b16 v[104:105], v7 offset:10240
    ds_read_b64_tr_b16 v[106:107], v7 offset:11264
    ds_read_b64_tr_b16 v[108:109], v8 offset:10240
    ds_read_b64_tr_b16 v[110:111], v8 offset:11264
    s_waitcnt lgkmcnt(8)
    ds_read_b64_tr_b16 v[112:113], v7 offset:12288
    ds_read_b64_tr_b16 v[114:115], v7 offset:13312
    ds_read_b64_tr_b16 v[116:117], v8 offset:12288
    ds_read_b64_tr_b16 v[118:119], v8 offset:13312
    s_waitcnt lgkmcnt(8)
    ds_read_b64_tr_b16 v[120:121], v7 offset:14336
    ds_read_b64_tr_b16 v[122:123], v7 offset:15360
    ds_read_b64_tr_b16 v[124:125], v8 offset:14336
    ds_read_b64_tr_b16 v[126:127], v8 offset:15360
    v_lshlrev_b32 v6, 10, v4
    v_lshrrev_b32 v9, 5, v0
    v_lshl_add_u32 v6, v9, 4, v6
    s_lshl_b32 s61, s44, 15
    s_add_u32 s61, s61, s45
    s_lshl_b32 s39, s63, 5
    s_add_u32 s61, s61, s39
    s_mov_b32 s4, s12
    s_mov_b32 s5, s13
    s_mov_b32 s6, 0x200000
    s_mov_b32 s7, 0x20000
    s_mul_i32 s38, s62, 27648
    s_add_u32 s38, s38, 98304
    v_add_u32 v10, s38, v1
    v_mul_f32 v184, v184, v245
    v_mul_f32 v185, v185, v245
    v_mul_f32 v186, v186, v245
    v_mul_f32 v187, v187, v245
    v_mul_f32 v188, v188, v245
    v_mul_f32 v189, v189, v245
    v_mul_f32 v190, v190, v245
    v_mul_f32 v191, v191, v245
    v_mul_f32 v192, v192, v245
    v_mul_f32 v193, v193, v245
    v_mul_f32 v194, v194, v245
    v_mul_f32 v195, v195, v245
    v_mul_f32 v196, v196, v245
    v_mul_f32 v197, v197, v245
    v_mul_f32 v198, v198, v245
    v_mul_f32 v199, v199, v245
    v_mul_f32 v200, v200, v245
    v_mul_f32 v201, v201, v245
    v_mul_f32 v202, v202, v245
    v_mul_f32 v203, v203, v245
    v_mul_f32 v204, v204, v245
    v_mul_f32 v205, v205, v245
    v_mul_f32 v206, v206, v245
    v_mul_f32 v207, v207, v245
    v_mul_f32 v208, v208, v245
    v_mul_f32 v209, v209, v245
    v_mul_f32 v210, v210, v245
    v_mul_f32 v211, v211, v245
    v_mul_f32 v212, v212, v245
    v_mul_f32 v213, v213, v245
    v_mul_f32 v214, v214, v245
    v_mul_f32 v215, v215, v245
    s_waitcnt lgkmcnt(0)
    s_mov_b32 s38, 0x8000
    s_waitcnt vmcnt(7)
KF_O0:
    v_max3_u32 v11, v128, v129, v130
    v_max_u32 v11, v11, v131
    v_cmp_eq_u32 vcc, -1, v11
    s_nop 0
    s_cbranch_vccnz KF_O0_RE
KF_O0_OK:
    v_mfma_f32_32x32x16_bf16 v[184:199], v[64:67], v[128:131], v[184:199]
    v_mfma_f32_32x32x16_bf16 v[200:215], v[68:71], v[128:131], v[200:215]
    s_waitcnt vmcnt(6)
KF_O1:
    v_max3_u32 v11, v132, v133, v134
    v_max_u32 v11, v11, v135
    v_cmp_eq_u32 vcc, -1, v11
    s_nop 0
    s_cbranch_vccnz KF_O1_RE
KF_O1_OK:
    v_mfma_f32_32x32x16_bf16 v[184:199], v[72:75], v[132:135], v[184:199]
    v_mfma_f32_32x32x16_bf16 v[200:215], v[76:79], v[132:135], v[200:215]
    s_waitcnt vmcnt(5)
KF_O2:
    v_max3_u32 v11, v136, v137, v138
    v_max_u32 v11, v11, v139
    v_cmp_eq_u32 vcc, -1, v11
    s_nop 0
    s_cbranch_vccnz KF_O2_RE
KF_O2_OK:
    v_mfma_f32_32x32x16_bf16 v[184:199], v[80:83], v[136:139], v[184:199]
    v_mfma_f32_32x32x16_bf16 v[200:215], v[84:87], v[136:139], v[200:215]
    s_waitcnt vmcnt(4)
KF_O3:
    v_max3_u32 v11, v140, v141, v142
    v_max_u32 v11, v11, v143
    v_cmp_eq_u32 vcc, -1, v11
    s_nop 0
    s_cbranch_vccnz KF_O3_RE
KF_O3_OK:
    v_mfma_f32_32x32x16_bf16 v[184:199], v[88:91], v[140:143], v[184:199]
    v_mfma_f32_32x32x16_bf16 v[200:215], v[92:95], v[140:143], v[200:215]
    s_waitcnt vmcnt(3)
KF_O4:
    v_max3_u32 v11, v144, v145, v146
    v_max_u32 v11, v11, v147
    v_cmp_eq_u32 vcc, -1, v11
    s_nop 0
    s_cbranch_vccnz KF_O4_RE
KF_O4_OK:
    v_mfma_f32_32x32x16_bf16 v[184:199], v[96:99], v[144:147], v[184:199]
    v_mfma_f32_32x32x16_bf16 v[200:215], v[100:103], v[144:147], v[200:215]
    s_waitcnt vmcnt(2)
KF_O5:
    v_max3_u32 v11, v148, v149, v150
    v_max_u32 v11, v11, v151
    v_cmp_eq_u32 vcc, -1, v11
    s_nop 0
    s_cbranch_vccnz KF_O5_RE
KF_O5_OK:
    v_mfma_f32_32x32x16_bf16 v[184:199], v[104:107], v[148:151], v[184:199]
    v_mfma_f32_32x32x16_bf16 v[200:215], v[108:111], v[148:151], v[200:215]
    s_waitcnt vmcnt(1)
KF_O6:
    v_max3_u32 v11, v152, v153, v154
    v_max_u32 v11, v11, v155
    v_cmp_eq_u32 vcc, -1, v11
    s_nop 0
    s_cbranch_vccnz KF_O6_RE
KF_O6_OK:
    v_mfma_f32_32x32x16_bf16 v[184:199], v[112:115], v[152:155], v[184:199]
    v_mfma_f32_32x32x16_bf16 v[200:215], v[116:119], v[152:155], v[200:215]
    s_waitcnt vmcnt(0)
KF_O7:
    v_max3_u32 v11, v156, v157, v158
    v_max_u32 v11, v11, v159
    v_cmp_eq_u32 vcc, -1, v11
    s_nop 0
    s_cbranch_vccnz KF_O7_RE
KF_O7_OK:
    v_mfma_f32_32x32x16_bf16 v[184:199], v[120:123], v[156:159], v[184:199]
    v_mfma_f32_32x32x16_bf16 v[200:215], v[124:127], v[156:159], v[200:215]
    s_cmp_ge_u32 s63, 2
    s_nop 9
    s_cbranch_scc1 KF_X2
    s_cmp_eq_u32 s63, 1
    s_cbranch_scc1 KF_X1
    ds_write_b128 v242, v[192:195] offset:0
    ds_write_b128 v242, v[196:199] offset:1024
    ds_write_b128 v242, v[200:203] offset:2048
    ds_write_b128 v242, v[204:207] offset:3072
    ds_write_b128 v242, v[208:211] offset:4096
    ds_write_b128 v242, v[212:215] offset:5120
    s_waitcnt lgkmcnt(0)
    s_barrier
    ds_read_b128 v[32:35], v10 offset:6912
    ds_read_b128 v[36:39], v10 offset:7936
    ds_read_b128 v[40:43], v10 offset:13824
    ds_read_b128 v[44:47], v10 offset:14848
    ds_read_b128 v[48:51], v10 offset:20736
    ds_read_b128 v[52:55], v10 offset:21760
    s_waitcnt lgkmcnt(4)
    v_add_f32 v32, v32, v184
    v_add_f32 v33, v33, v185
    v_add_f32 v34, v34, v186
    v_add_f32 v35, v35, v187
    v_add_f32 v36, v36, v188
    v_add_f32 v37, v37, v189
    v_add_f32 v38, v38, v190
    v_add_f32 v39, v39, v191
    s_waitcnt lgkmcnt(0)
    v_add_f32 v40, v40, v48
    v_add_f32 v41, v41, v49
    v_add_f32 v42, v42, v50
    v_add_f32 v43, v43, v51
    v_add_f32 v44, v44, v52
    v_add_f32 v45, v45, v53
    v_add_f32 v46, v46, v54
    v_add_f32 v47, v47, v55
    v_add_f32 v32, v32, v40
    v_add_f32 v33, v33, v41
    v_add_f32 v34, v34, v42
    v_add_f32 v35, v35, v43
    v_add_f32 v36, v36, v44
    v_add_f32 v37, v37, v45
    v_add_f32 v38, v38, v46
    v_add_f32 v39, v39, v47
    v_cvt_pk_bf16_f32 v56, v32, v33
    v_cvt_pk_bf16_f32 v57, v34, v35
    v_cvt_pk_bf16_f32 v58, v36, v37
    v_cvt_pk_bf16_f32 v59, v38, v39
    s_nop 1
    v_permlane32_swap_b32 v56, v58
    v_permlane32_swap_b32 v57, v59
    buffer_store_dwordx4 v[56:59], v6, s[4:7], s61 offen
    s_endpgm
KF_X1:
    ds_write_b128 v242, v[184:187] offset:0
    ds_write_b128 v242, v[188:191] offset:1024
    ds_write_b128 v242, v[200:203] offset:2048
    ds_write_b128 v242, v[204:207] offset:3072
    ds_write_b128 v242, v[208:211] offset:4096
    ds_write_b128 v242, v[212:215] offset:5120
    s_waitcnt lgkmcnt(0)
    s_barrier
    ds_read_b128 v[32:35], v10 offset:0
    ds_read_b128 v[36:39], v10 offset:1024
    ds_read_b128 v[40:43], v10 offset:15872
    ds_read_b128 v[44:47], v10 offset:16896
    ds_read_b128 v[48:51], v10 offset:22784
    ds_read_b128 v[52:55], v10 offset:23808
    s_waitcnt lgkmcnt(4)
    v_add_f32 v32, v32, v192
    v_add_f32 v33, v33, v193
    v_add_f32 v34, v34, v194
    v_add_f32 v35, v35, v195
    v_add_f32 v36, v36, v196
    v_add_f32 v37, v37, v197
    v_add_f32 v38, v38, v198
    v_add_f32 v39, v39, v199
    s_waitcnt lgkmcnt(0)
    v_add_f32 v40, v40, v48
    v_add_f32 v41, v41, v49
    v_add_f32 v42, v42, v50
    v_add_f32 v43, v43, v51
    v_add_f32 v44, v44, v52
    v_add_f32 v45, v45, v53
    v_add_f32 v46, v46, v54
    v_add_f32 v47, v47, v55
    v_add_f32 v32, v32, v40
    v_add_f32 v33, v33, v41
    v_add_f32 v34, v34, v42
    v_add_f32 v35, v35, v43
    v_add_f32 v36, v36, v44
    v_add_f32 v37, v37, v45
    v_add_f32 v38, v38, v46
    v_add_f32 v39, v39, v47
    v_cvt_pk_bf16_f32 v56, v32, v33
    v_cvt_pk_bf16_f32 v57, v34, v35
    v_cvt_pk_bf16_f32 v58, v36, v37
    v_cvt_pk_bf16_f32 v59, v38, v39
    s_nop 1
    v_permlane32_swap_b32 v56, v58
    v_permlane32_swap_b32 v57, v59
    buffer_store_dwordx4 v[56:59], v6, s[4:7], s61 offen
    s_endpgm
KF_X2:
    s_cmp_eq_u32 s63, 3
    s_cbranch_scc1 KF_X3
    ds_write_b128 v242, v[184:187] offset:0
    ds_write_b128 v242, v[188:191] offset:1024
    ds_write_b128 v242, v[192:195] offset:2048
    ds_write_b128 v242, v[196:199] offset:3072
    ds_write_b128 v242, v[208:211] offset:4096
    ds_write_b128 v242, v[212:215] offset:5120
    s_waitcnt lgkmcnt(0)
    s_barrier
    ds_read_b128 v[32:35], v10 offset:2048
    ds_read_b128 v[36:39], v10 offset:3072
    ds_read_b128 v[40:43], v10 offset:8960
    ds_read_b128 v[44:47], v10 offset:9984
    ds_read_b128 v[48:51], v10 offset:24832
    ds_read_b128 v[52:55], v10 offset:25856
    s_waitcnt lgkmcnt(4)
    v_add_f32 v32, v32, v200
    v_add_f32 v33, v33, v201
    v_add_f32 v34, v34, v202
    v_add_f32 v35, v35, v203
    v_add_f32 v36, v36, v204
    v_add_f32 v37, v37, v205
    v_add_f32 v38, v38, v206
    v_add_f32 v39, v39, v207
    s_waitcnt lgkmcnt(0)
    v_add_f32 v40, v40, v48
    v_add_f32 v41, v41, v49
    v_add_f32 v42, v42, v50
    v_add_f32 v43, v43, v51
    v_add_f32 v44, v44, v52
    v_add_f32 v45, v45, v53
    v_add_f32 v46, v46, v54
    v_add_f32 v47, v47, v55
    v_add_f32 v32, v32, v40
    v_add_f32 v33, v33, v41
    v_add_f32 v34, v34, v42
    v_add_f32 v35, v35, v43
    v_add_f32 v36, v36, v44
    v_add_f32 v37, v37, v45
    v_add_f32 v38, v38, v46
    v_add_f32 v39, v39, v47
    v_cvt_pk_bf16_f32 v56, v32, v33
    v_cvt_pk_bf16_f32 v57, v34, v35
    v_cvt_pk_bf16_f32 v58, v36, v37
    v_cvt_pk_bf16_f32 v59, v38, v39
    s_nop 1
    v_permlane32_swap_b32 v56, v58
    v_permlane32_swap_b32 v57, v59
    buffer_store_dwordx4 v[56:59], v6, s[4:7], s61 offen
    s_endpgm
KF_X3:
    ds_write_b128 v242, v[184:187] offset:0
    ds_write_b128 v242, v[188:191] offset:1024
    ds_write_b128 v242, v[192:195] offset:2048
    ds_write_b128 v242, v[196:199] offset:3072
    ds_write_b128 v242, v[200:203] offset:4096
    ds_write_b128 v242, v[204:207] offset:5120
    s_waitcnt lgkmcnt(0)
    s_barrier
    ds_read_b128 v[32:35], v10 offset:4096
    ds_read_b128 v[36:39], v10 offset:5120
    ds_read_b128 v[40:43], v10 offset:11008
    ds_read_b128 v[44:47], v10 offset:12032
    ds_read_b128 v[48:51], v10 offset:17920
    ds_read_b128 v[52:55], v10 offset:18944
    s_waitcnt lgkmcnt(4)
    v_add_f32 v32, v32, v208
    v_add_f32 v33, v33, v209
    v_add_f32 v34, v34, v210
    v_add_f32 v35, v35, v211
    v_add_f32 v36, v36, v212
    v_add_f32 v37, v37, v213
    v_add_f32 v38, v38, v214
    v_add_f32 v39, v39, v215
    s_waitcnt lgkmcnt(0)
    v_add_f32 v40, v40, v48
    v_add_f32 v41, v41, v49
    v_add_f32 v42, v42, v50
    v_add_f32 v43, v43, v51
    v_add_f32 v44, v44, v52
    v_add_f32 v45, v45, v53
    v_add_f32 v46, v46, v54
    v_add_f32 v47, v47, v55
    v_add_f32 v32, v32, v40
    v_add_f32 v33, v33, v41
    v_add_f32 v34, v34, v42
    v_add_f32 v35, v35, v43
    v_add_f32 v36, v36, v44
    v_add_f32 v37, v37, v45
    v_add_f32 v38, v38, v46
    v_add_f32 v39, v39, v47
    v_cvt_pk_bf16_f32 v56, v32, v33
    v_cvt_pk_bf16_f32 v57, v34, v35
    v_cvt_pk_bf16_f32 v58, v36, v37
    v_cvt_pk_bf16_f32 v59, v38, v39
    s_nop 1
    v_permlane32_swap_b32 v56, v58
    v_permlane32_swap_b32 v57, v59
    buffer_store_dwordx4 v[56:59], v6, s[4:7], s61 offen
    s_endpgm
KF_END:
    s_endpgm
KF_EV:
    s_sub_u32 s37, s37, 1
    s_cmp_eq_u32 s37, 3
    s_cbranch_scc0 KF_EV2
    buffer_load_dword v20, v21, s[80:83], s96 offen sc1
    s_branch KF_EVR
KF_EV2:
    s_mov_b32 s37, 0
    s_waitcnt vmcnt(14)
    v_cmp_le_u32 vcc, 1, v20
    s_mov_b32 s38, 0x8000
    s_cmp_eq_u64 vcc, -1
    s_cbranch_scc1 KF_S2_OK
KF_S2:
    s_sleep 4
    buffer_load_dword v20, v21, s[80:83], s96 offen sc1
    s_sub_u32 s38, s38, 1
    s_waitcnt vmcnt(0)
    v_cmp_le_u32 vcc, 1, v20
    s_cselect_b32 s39, 1, 0
    s_cmp_eq_u64 vcc, -1
    s_cselect_b32 s39, 1, s39
    s_cmp_eq_u32 s39, 0
    s_cbranch_scc1 KF_S2
KF_S2_OK:
    v_cmp_lt_u32 vcc, v235, v232
    s_nop 4
    s_branch KF_EVR
KF_P0:
    s_mov_b32 s38, 0x40000
    s_setprio 0
KF_P0_L:
    s_sleep 1
    ds_read_b32 v235, v234
    s_sub_u32 s38, s38, 1
    s_waitcnt lgkmcnt(0)
    v_cmp_lt_u32 vcc, v235, v232
    s_cbranch_scc1 KF_P0_GO
    s_cbranch_vccnz KF_P0_L
KF_P0_GO:
    s_setprio 3
    s_branch KF_P0_OK
KF_P1:
    s_mov_b32 s38, 0x40000
    s_setprio 0
KF_P1_L:
    s_sleep 1
    ds_read_b32 v235, v234
    s_sub_u32 s38, s38, 1
    s_waitcnt lgkmcnt(0)
    v_cmp_lt_u32 vcc, v235, v232
    s_cbranch_scc1 KF_P1_GO
    s_cbranch_vccnz KF_P1_L
KF_P1_GO:
    s_setprio 3
    s_branch KF_P1_OK
KF_P2:
    s_mov_b32 s38, 0x40000
    s_setprio 0
KF_P2_L:
    s_sleep 1
    ds_read_b32 v235, v234
    s_sub_u32 s38, s38, 1
    s_waitcnt lgkmcnt(0)
    v_cmp_lt_u32 vcc, v235, v232
    s_cbranch_scc1 KF_P2_GO
    s_cbranch_vccnz KF_P2_L
KF_P2_GO:
    s_setprio 3
    s_branch KF_P2_OK
KF_P3:
    s_mov_b32 s38, 0x40000
    s_setprio 0
KF_P3_L:
    s_sleep 1
    ds_read_b32 v235, v234
    s_sub_u32 s38, s38, 1
    s_waitcnt lgkmcnt(0)
    v_cmp_lt_u32 vcc, v235, v232
    s_cbranch_scc1 KF_P3_GO
    s_cbranch_vccnz KF_P3_L
KF_P3_GO:
    s_setprio 3
    s_branch KF_P3_OK
KF_O0_RE:
    s_sub_u32 s38, s38, 1
    s_cbranch_scc1 KF_O0_GU
    s_sleep 1
    buffer_load_dwordx4 v[128:131], v1, s[52:55], s60 offen offset:0 sc1
    buffer_load_dwordx4 v[132:135], v1, s[52:55], s60 offen offset:1024 sc1
    buffer_load_dwordx4 v[136:139], v1, s[52:55], s60 offen offset:2048 sc1
    buffer_load_dwordx4 v[140:143], v1, s[52:55], s60 offen offset:3072 sc1
    buffer_load_dwordx4 v[144:147], v1, s[52:55], s47 offen offset:0 sc1
    buffer_load_dwordx4 v[148:151], v1, s[52:55], s47 offen offset:1024 sc1
    buffer_load_dwordx4 v[152:155], v1, s[52:55], s47 offen offset:2048 sc1
    buffer_load_dwordx4 v[156:159], v1, s[52:55], s47 offen offset:3072 sc1
    s_waitcnt vmcnt(0)
    s_branch KF_O0
KF_O0_GU:
    s_mov_b32 s38, 0
    s_branch KF_O0_OK
KF_O1_RE:
    s_sub_u32 s38, s38, 1
    s_cbranch_scc1 KF_O1_GU
    s_sleep 1
    buffer_load_dwordx4 v[132:135], v1, s[52:55], s60 offen offset:1024 sc1
    buffer_load_dwordx4 v[136:139], v1, s[52:55], s60 offen offset:2048 sc1
    buffer_load_dwordx4 v[140:143], v1, s[52:55], s60 offen offset:3072 sc1
    buffer_load_dwordx4 v[144:147], v1, s[52:55], s47 offen offset:0 sc1
    buffer_load_dwordx4 v[148:151], v1, s[52:55], s47 offen offset:1024 sc1
    buffer_load_dwordx4 v[152:155], v1, s[52:55], s47 offen offset:2048 sc1
    buffer_load_dwordx4 v[156:159], v1, s[52:55], s47 offen offset:3072 sc1
    s_waitcnt vmcnt(0)
    s_branch KF_O1
KF_O1_GU:
    s_mov_b32 s38, 0
    s_branch KF_O1_OK
KF_O2_RE:
    s_sub_u32 s38, s38, 1
    s_cbranch_scc1 KF_O2_GU
    s_sleep 1
    buffer_load_dwordx4 v[136:139], v1, s[52:55], s60 offen offset:2048 sc1
    buffer_load_dwordx4 v[140:143], v1, s[52:55], s60 offen offset:3072 sc1
    buffer_load_dwordx4 v[144:147], v1, s[52:55], s47 offen offset:0 sc1
    buffer_load_dwordx4 v[148:151], v1, s[52:55], s47 offen offset:1024 sc1
    buffer_load_dwordx4 v[152:155], v1, s[52:55], s47 offen offset:2048 sc1
    buffer_load_dwordx4 v[156:159], v1, s[52:55], s47 offen offset:3072 sc1
    s_waitcnt vmcnt(0)
    s_branch KF_O2
KF_O2_GU:
    s_mov_b32 s38, 0
    s_branch KF_O2_OK
KF_O3_RE:
    s_sub_u32 s38, s38, 1
    s_cbranch_scc1 KF_O3_GU
    s_sleep 1
    buffer_load_dwordx4 v[140:143], v1, s[52:55], s60 offen offset:3072 sc1
    buffer_load_dwordx4 v[144:147], v1, s[52:55], s47 offen offset:0 sc1
    buffer_load_dwordx4 v[148:151], v1, s[52:55], s47 offen offset:1024 sc1
    buffer_load_dwordx4 v[152:155], v1, s[52:55], s47 offen offset:2048 sc1
    buffer_load_dwordx4 v[156:159], v1, s[52:55], s47 offen offset:3072 sc1
    s_waitcnt vmcnt(0)
    s_branch KF_O3
KF_O3_GU:
    s_mov_b32 s38, 0
    s_branch KF_O3_OK
KF_O4_RE:
    s_sub_u32 s38, s38, 1
    s_cbranch_scc1 KF_O4_GU
    s_sleep 1
    buffer_load_dwordx4 v[144:147], v1, s[52:55], s47 offen offset:0 sc1
    buffer_load_dwordx4 v[148:151], v1, s[52:55], s47 offen offset:1024 sc1
    buffer_load_dwordx4 v[152:155], v1, s[52:55], s47 offen offset:2048 sc1
    buffer_load_dwordx4 v[156:159], v1, s[52:55], s47 offen offset:3072 sc1
    s_waitcnt vmcnt(0)
    s_branch KF_O4
KF_O4_GU:
    s_mov_b32 s38, 0
    s_branch KF_O4_OK
KF_O5_RE:
    s_sub_u32 s38, s38, 1
    s_cbranch_scc1 KF_O5_GU
    s_sleep 1
    buffer_load_dwordx4 v[148:151], v1, s[52:55], s47 offen offset:1024 sc1
    buffer_load_dwordx4 v[152:155], v1, s[52:55], s47 offen offset:2048 sc1
    buffer_load_dwordx4 v[156:159], v1, s[52:55], s47 offen offset:3072 sc1
    s_waitcnt vmcnt(0)
    s_branch KF_O5
KF_O5_GU:
    s_mov_b32 s38, 0
    s_branch KF_O5_OK
KF_O6_RE:
    s_sub_u32 s38, s38, 1
    s_cbranch_scc1 KF_O6_GU
    s_sleep 1
    buffer_load_dwordx4 v[152:155], v1, s[52:55], s47 offen offset:2048 sc1
    buffer_load_dwordx4 v[156:159], v1, s[52:55], s47 offen offset:3072 sc1
    s_waitcnt vmcnt(0)
    s_branch KF_O6
KF_O6_GU:
    s_mov_b32 s38, 0
    s_branch KF_O6_OK
KF_O7_RE:
    s_sub_u32 s38, s38, 1
    s_cbranch_scc1 KF_O7_GU
    s_sleep 1
    buffer_load_dwordx4 v[156:159], v1, s[52:55], s47 offen offset:3072 sc1
    s_waitcnt vmcnt(0)
    s_branch KF_O7
KF_O7_GU:
    s_mov_b32 s38, 0
    s_branch KF_O7_OK
    s_endpgm
KF_SLOW:
    s_waitcnt vmcnt(0)
    s_add_u32 s72, s73, 0x200000
    s_add_u32 s8, s14, s72
    s_addc_u32 s9, s15, 0
    s_mov_b32 s10, 0x10000
    s_mov_b32 s11, 0x20000
    s_add_u32 s72, s73, 0x400000
    s_add_u32 s64, s14, s72
    s_addc_u32 s65, s15, 0
    s_mov_b32 s66, 0x10000
    s_mov_b32 s67, 0x20000
    s_mov_b32 s72, 0
    v_mov_b32 v4, 0xff800000
    s_mov_b32 s46, 64
KF_SL1:
    buffer_load_dwordx4 v[144:147], v1, s[8:11], s72 offen sc1
    s_add_u32 s72, s72, 1024
    s_waitcnt vmcnt(0)
    v_mfma_f32_32x32x16_bf16 v[32:47], v[144:147], v[140:143], 0
    s_nop 15
    v_max3_f32 v4, v4, v32, v33
    v_max3_f32 v4, v4, v34, v35
    v_max3_f32 v4, v4, v36, v37
    v_max3_f32 v4, v4, v38, v39
    v_max3_f32 v4, v4, v40, v41
    v_max3_f32 v4, v4, v42, v43
    v_max3_f32 v4, v4, v44, v45
    v_max3_f32 v4, v4, v46, v47
    s_sub_u32 s46, s46, 1
    s_cmp_lg_u32 s46, 0
    s_cbranch_scc1 KF_SL1
    v_mov_b32 v5, v4
    s_nop 1
    v_permlane32_swap_b32 v4, v5
    s_nop 1
    v_max_f32 v4, v4, v5
    v_sub_f32 v64, 0, v4
    v_sub_f32 v65, 0, v4
    v_sub_f32 v66, 0, v4
    v_sub_f32 v67, 0, v4
    v_sub_f32 v68, 0, v4
    v_sub_f32 v69, 0, v4
    v_sub_f32 v70, 0, v4
    v_sub_f32 v71, 0, v4
    v_sub_f32 v72, 0, v4
    v_sub_f32 v73, 0, v4
    v_sub_f32 v74, 0, v4
    v_sub_f32 v75, 0, v4
    v_sub_f32 v76, 0, v4
    v_sub_f32 v77, 0, v4
    v_sub_f32 v78, 0, v4
    v_sub_f32 v79, 0, v4
    v_mov_b32 v112, 0
    v_mov_b32 v113, 0
    v_mov_b32 v114, 0
    v_mov_b32 v115, 0
    v_mov_b32 v116, 0
    v_mov_b32 v117, 0
    v_mov_b32 v118, 0
    v_mov_b32 v119, 0
    v_mov_b32 v120, 0
    v_mov_b32 v121, 0
    v_mov_b32 v122, 0
    v_mov_b32 v123, 0
    v_mov_b32 v124, 0
    v_mov_b32 v125, 0
    v_mov_b32 v126, 0
    v_mov_b32 v127, 0
    s_mov_b32 s72, 0
    s_mov_b32 s46, 65
KF_SL2:
    buffer_load_dwordx4 v[144:147], v1, s[8:11], s72 offen sc1
    s_mov_b64 exec, s[74:75]
    buffer_load_dwordx4 v[152:155], v18, s[64:67], s72 offen sc1
    buffer_load_dwordx4 v[156:159], v18, s[64:67], s72 offen offset:512 sc1
    s_mov_b64 exec, -1
    s_add_u32 s72, s72, 1024
    s_waitcnt vmcnt(0)
    v_mfma_f32_32x32x16_bf16 v[32:47], v[144:147], v[140:143], v[64:79]
    s_nop 15
    v_exp_f32 v32, v32
    v_exp_f32 v33, v33
    v_exp_f32 v34, v34
    v_exp_f32 v35, v35
    v_exp_f32 v36, v36
    v_exp_f32 v37, v37
    v_exp_f32 v38, v38
    v_exp_f32 v39, v39
    v_exp_f32 v40, v40
    v_exp_f32 v41, v41
    v_exp_f32 v42, v42
    v_exp_f32 v43, v43
    v_exp_f32 v44, v44
    v_exp_f32 v45, v45
    v_exp_f32 v46, v46
    v_exp_f32 v47, v47
    s_nop 1
    v_smfmac_f32_32x32x32_bf16 v[112:127], v[152:155], v[32:39], v19
    v_smfmac_f32_32x32x32_bf16 v[112:127], v[156:159], v[40:47], v19
    s_sub_u32 s46, s46, 1
    s_cmp_lg_u32 s46, 1
    s_cbranch_scc1 KF_SL2
    s_nop 15
    s_branch KF_CHK
KF_LAST:
    s_endpgm
.section .rodata,"a"
.p2align 6
.amdhsa_kernel gated_mix__softmax_full_mha__swiglu_ffn__prompt_kernel
  .amdhsa_next_free_vgpr 256
  .amdhsa_next_free_sgpr 102
  .amdhsa_accum_offset 256
  .amdhsa_group_segment_fixed_size 0
  .amdhsa_kernarg_size 88
  .amdhsa_user_sgpr_count 2
  .amdhsa_user_sgpr_kernarg_segment_ptr 1
  .amdhsa_system_sgpr_workgroup_id_x 1
  .amdhsa_float_denorm_mode_32 3
.end_amdhsa_kernel
```
